```python
import torch

def _softmax(x, axis=-1):
    return torch.softmax(x, dim=axis)
def _gelu(x):
    return torch.nn.functional.gelu(x, approximate="tanh")
def _silu(x):
    return torch.nn.functional.silu(x)
def _sigmoid(x):
    return torch.sigmoid(x)
def _layernorm(x, axis=-1, eps=1e-5):
    m = x.mean(dim=axis, keepdim=True)
    v = x.var(dim=axis, keepdim=True, unbiased=False)
    return (x - m) / torch.sqrt(v + eps)
def _scatter_add(tgt, idx, src, axis=0):
    return tgt.clone().index_add_(axis, idx, src)
def _segment_sum(src, seg, n):
    out = torch.zeros((n,) + src.shape[1:], dtype=src.dtype)
    return out.index_add_(0, seg, src)
def _pad(x, pw):
    flat = tuple(v for pair in reversed(pw) for v in pair)
    return torch.nn.functional.pad(x, flat)

kernel_name = 'recurrent_scan__ssm_conv_s4__dense_activation_mish__prompt'

def setup_inputs():

    _w = (lambda a: (lambda t: t.to(torch.bfloat16) if t.is_floating_point() else t)(torch.as_tensor(a)))
    def _A_setup():
        B, L, D, N = 1, 2048, 640, 192
        A_re = -(lambda _x: torch.exp(torch.as_tensor(_x)))((lambda *s: torch.randn(*s, dtype=torch.bfloat16) * 3.2)(D, N))
        A_im = torch.pi * (lambda *s: torch.randn(*s, dtype=torch.bfloat16) * 0.2)(D, N)
        B_re = (lambda *s: torch.randn(*s, dtype=torch.bfloat16) * 0.2)(D, N)
        B_im = (lambda *s: torch.randn(*s, dtype=torch.bfloat16) * 0.2)(D, N)
        C_re = (lambda *s: torch.randn(*s, dtype=torch.bfloat16) * 0.2)(D, N)
        C_im = (lambda *s: torch.randn(*s, dtype=torch.bfloat16) * 0.2)(D, N)
        log_dt = (lambda *s: torch.randn(*s, dtype=torch.bfloat16) * 0.2)(D) * 0.5 - 4.0
        Dskip = (lambda *s: torch.randn(*s, dtype=torch.bfloat16) * 0.2)(D)
        return {
            "u": _w((lambda *s: torch.randn(*s, dtype=torch.bfloat16) * 0.05)(B, L, D)),
            "A_re": _w(A_re),
            "A_im": _w(A_im),
            "B_re": _w(B_re),
            "B_im": _w(B_im),
            "C_re": _w(C_re),
            "C_im": _w(C_im),
            "log_dt": _w(log_dt),
            "Dskip": _w(Dskip),
        }
    _A_in = _A_setup()

    def _B_setup():
        B, S, D, F = 1, 2048, 640, 1536
        return {
            "x": _w((lambda *s: torch.randn(*s, dtype=torch.bfloat16) * 0.05)(B, S, D)),
            "w1": _w((lambda *s: torch.randn(*s, dtype=torch.bfloat16) * 0.8)(D, F) * (D ** -0.5)),
            "b1": _w((lambda *s: torch.randn(*s, dtype=torch.bfloat16) * 0.1)(F)),
            "w2": _w((lambda *s: torch.randn(*s, dtype=torch.bfloat16) * 0.1)(F, D) * (F ** -0.5)),
        }
    _B_in = _B_setup()

    return {
        "A_u": _A_in["u"],
        "A_A_re": _A_in["A_re"],
        "A_A_im": _A_in["A_im"],
        "A_B_re": _A_in["B_re"],
        "A_B_im": _A_in["B_im"],
        "A_C_re": _A_in["C_re"],
        "A_C_im": _A_in["C_im"],
        "A_log_dt": _A_in["log_dt"],
        "A_Dskip": _A_in["Dskip"],
        "B_x": _B_in["x"],
        "B_w1": _B_in["w1"],
        "B_b1": _B_in["b1"],
        "B_w2": _B_in["w2"],
    }

def reference(A_u, A_A_re, A_A_im, A_B_re, A_B_im, A_C_re, A_C_im, A_log_dt, A_Dskip, B_x, B_w1, B_b1, B_w2):
    def _A_ref(u, A_re, A_im, B_re, B_im, C_re, C_im, log_dt, Dskip):
        Bsz, L, D = u.shape
        dt = torch.exp(log_dt)[:, None]
        A = A_re + 1j * A_im
        Bc = B_re + 1j * B_im
        Cc = C_re + 1j * C_im
        logdA = dt * A
        dB = dt * Bc
        l = (lambda x, dt: x.to(dt))(torch.arange(L), A_re.dtype)
        P = torch.exp(logdA[:, :, None] * l[None, None, :])
        K = torch.einsum("dn,dnl,dn->dl", Cc, P, dB).real
        L2 = 2 * L
        Kp = _pad(K, ((0, 0), (0, L)))
        up = (lambda x, *d: x.permute(*d))(u, 0, 2, 1)
        up = _pad(up, ((0, 0), (0, 0), (0, L)))
        Kf = (lambda x, axes=(-2,-1): torch.fft.rfft2(x.float(), dim=axes))(Kp[:, None, :], axes=(-2, -1))
        Uf = (lambda x, axes=(-2,-1): torch.fft.rfft2(x.float(), dim=axes))(up[:, :, None, :], axes=(-2, -1))
        Yf = Uf * Kf[None, :, :, :]
        y = (lambda x, s, axes=(-2,-1): torch.fft.irfft2(x, s=s, dim=axes).to(torch.bfloat16))(Yf, (1, L2), axes=(-2, -1))[:, :, 0, :L]
        y = (lambda x, *d: x.permute(*d))(y, 0, 2, 1) + u * Dskip[None, None, :]
        return y

    def _B_ref(x, w1, b1, w2):
        h = torch.einsum("bsd,df->bsf", x, w1) + b1
        sp = torch.log1p(torch.exp(-torch.abs(h))) + torch.where(h > 0, h, torch.zeros_like(h))
        act = h * torch.tanh(sp)
        return torch.einsum("bsf,fd->bsd", act, w2)

    x = A_u
    xn = _layernorm(x, axis=-1)
    s = _A_ref(xn, A_A_re, A_A_im, A_B_re, A_B_im, A_C_re, A_C_im, A_log_dt, A_Dskip)
    g = _silu(_B_ref(xn, B_w1, B_b1, B_w2))
    return x + s * g
```

```asm
; @launch grid=(512,1,1) block=(256,1,1) lds=81920
.amdgcn_target "amdgcn-amd-amdhsa--gfx950"
.text
.globl recurrent_scan__ssm_conv_s4__dense_activation_mish__prompt_kernel
.p2align 8
.type recurrent_scan__ssm_conv_s4__dense_activation_mish__prompt_kernel,@function
recurrent_scan__ssm_conv_s4__dense_activation_mish__prompt_kernel:
    s_cmp_ge_u32 s2, 512
    s_cbranch_scc1 K_exit
    s_getpc_b64 s[18:19]
    s_and_b32 s18, s18, 0xffffff00
    s_lshr_b32 s3, s2, 3
    s_xor_b32 s3, s3, 32
    s_lshl_b32 s3, s3, 9
    s_add_u32 s18, s18, s3
    s_addc_u32 s19, s19, 0
    v_lshrrev_b32 v252, 6, v0
    v_lshlrev_b32 v252, 7, v252
    v_mov_b32 v253, s19
    v_add_co_u32 v252, vcc, s18, v252
    s_nop 1
    v_addc_co_u32 v253, vcc, 0, v253, vcc
    s_mov_b64 exec, 1
    global_load_dword v254, v[252:253], off
    s_mov_b64 exec, -1
    s_cmp_lt_u32 s2, 256
    s_cbranch_scc1 S_role
    s_load_dwordx2 s[20:21], s[0:1], 0
    s_load_dwordx2 s[24:25], s[0:1], 80
    s_load_dwordx2 s[52:53], s[0:1], 96
    v_lshrrev_b32 v2, 6, v0
    v_and_b32 v1, 63, v0
    v_readfirstlane_b32 s12, v2
    s_sub_u32 s3, s2, 256
    s_mov_b32 s22, 2621440
    s_mov_b32 s23, 0x20000
    s_mov_b32 s26, 1966080
    s_mov_b32 s27, 0x20000
    s_lshr_b32 s17, s3, 3
    s_lshl_b32 s17, s17, 2
    s_add_u32 s17, s17, s12
    v_mul_u32_u24 v3, 0xaaab, v1
    v_lshrrev_b32 v3, 18, v3
    v_mul_u32_u24 v4, 6, v3
    v_sub_u32 v4, v1, v4
    v_mul_u32_u24 v3, 196608, v3
    v_lshl_add_u32 v3, v4, 7, v3
    s_lshr_b32 s16, s17, 1
    s_mul_i32 s16, s16, 3072
    s_and_b32 s15, s3, 1
    s_lshl_b32 s15, s15, 1
    s_and_b32 s36, s17, 1
    s_add_u32 s15, s15, s36
    s_mul_i32 s15, s15, 768
    s_add_u32 s16, s16, s15
    v_add_u32 v109, s16, v3
    v_lshrrev_b32 v4, 2, v1
    v_lshlrev_b32 v4, 7, v4
    v_and_b32 v5, 3, v1
    v_mul_u32_u24 v5, 1280, v5
    v_add_u32 v4, v4, v5
    s_bfe_u32 s15, s3, 0x20001
    s_lshl_b32 s15, s15, 7
    s_add_u32 s15, s15, s17
    s_mul_i32 s15, s15, 5120
    v_add_u32 v108, s15, v4
    s_waitcnt lgkmcnt(0)
    s_mov_b32 exec_lo, 0xff
    s_mov_b32 exec_hi, 0x0
    buffer_load_dword v182, v108, s[20:23], 0 offen
    s_mov_b32 exec_lo, 0xfff
    s_mov_b32 exec_hi, 0x0
    buffer_load_dword v182, v109, s[24:27], 0 offen
    s_mov_b64 exec, -1
    s_mov_b32 s54, 1966080
    s_mov_b32 s55, 0x20000
    s_mul_i32 s15, s17, 1920
    v_lshl_add_u32 v181, v1, 7, s15
    s_load_dwordx2 s[28:29], s[0:1], 88
    s_load_dwordx2 s[4:5], s[0:1], 120
    s_load_dwordx2 s[8:9], s[0:1], 112
    s_load_dwordx2 s[32:33], s[0:1], 104
    s_mov_b32 s30, 3072
    s_mov_b32 s31, 0x20000
    s_mov_b32 s6, 23068672
    s_mov_b32 s7, 0x20000
    s_mov_b32 s10, 256
    s_mov_b32 s11, 0x20000
    s_mov_b32 s34, 2621440
    s_mov_b32 s35, 0x20000
    s_and_b32 s15, s3, 7
    s_lshr_b32 s16, s3, 3
    s_lshr_b32 s36, s15, 1
    s_lshl_b32 s38, s15, 2
    s_lshl_b32 s36, s36, 2
    s_and_b32 s17, s16, 3
    s_add_u32 s36, s36, s17
    s_add_u32 s38, s38, s17
    s_and_b32 s15, s15, 1
    s_lshl_b32 s37, s15, 3
    s_lshr_b32 s39, s16, 2
    s_add_u32 s37, s37, s39
    v_mov_b32 v6, 0
    v_lshlrev_b32 v8, 4, v1
    v_add_u32 v2, 0, v1
    v_mul_u32_u24 v3, 0xaaab, v2
    v_lshrrev_b32 v3, 19, v3
    v_mul_u32_u24 v4, 12, v3
    v_sub_u32 v4, v2, v4
    v_lshrrev_b32 v5, 2, v3
    v_and_b32 v5, 2, v5
    v_xor_b32 v4, v4, v5
    v_lshlrev_b32 v4, 4, v4
    v_mul_u32_u24 v3, 3072, v3
    v_add_u32 v174, v3, v4
    v_add_u32 v2, 64, v1
    v_mul_u32_u24 v3, 0xaaab, v2
    v_lshrrev_b32 v3, 19, v3
    v_mul_u32_u24 v4, 12, v3
    v_sub_u32 v4, v2, v4
    v_lshrrev_b32 v5, 2, v3
    v_and_b32 v5, 2, v5
    v_xor_b32 v4, v4, v5
    v_lshlrev_b32 v4, 4, v4
    v_mul_u32_u24 v3, 3072, v3
    v_add_u32 v175, v3, v4
    v_subrev_u32 v175, 1024, v175
    v_add_u32 v2, 128, v1
    v_mul_u32_u24 v3, 0xaaab, v2
    v_lshrrev_b32 v3, 19, v3
    v_mul_u32_u24 v4, 12, v3
    v_sub_u32 v4, v2, v4
    v_lshrrev_b32 v5, 2, v3
    v_and_b32 v5, 2, v5
    v_xor_b32 v4, v4, v5
    v_lshlrev_b32 v4, 4, v4
    v_mul_u32_u24 v3, 3072, v3
    v_add_u32 v176, v3, v4
    v_subrev_u32 v176, 2048, v176
    s_mul_i32 s43, s12, 49152
    s_mul_i32 s15, s37, 192
    s_add_u32 s43, s43, s15
    s_mul_i32 s45, s12, 3072
    v_lshrrev_b32 v2, 3, v1
    v_and_b32 v3, 7, v1
    v_lshrrev_b32 v4, 1, v2
    v_xor_b32 v3, v3, v4
    v_mul_u32_u24 v2, 1280, v2
    v_lshl_add_u32 v177, v3, 4, v2
    v_xor_b32 v178, 64, v177
    v_add_u32 v178, 9216, v178
    s_lshl_b32 s44, s36, 7
    s_lshl_b32 s15, s12, 5
    s_add_u32 s44, s44, s15
    s_mul_i32 s44, s44, 1280
    s_mul_i32 s46, s12, 11264
    s_add_u32 s46, s46, 36864
    s_add_u32 m0, s45, 0
    s_nop 0
    buffer_load_dwordx4 v174, s[24:27], s43 offen offset:0 lds
    buffer_load_dwordx4 v175, s[24:27], s43 offen offset:1024 lds
    buffer_load_dwordx4 v176, s[24:27], s43 offen offset:2048 lds
    s_add_u32 m0, s46, 0
    s_add_u32 s15, s44, 0
    buffer_load_dwordx4 v177, s[20:23], s15 offen offset:0 lds
    buffer_load_dwordx4 v178, s[20:23], s15 offen offset:1024 lds
    s_add_u32 m0, s46, 2048
    s_add_u32 s15, s44, 20480
    buffer_load_dwordx4 v177, s[20:23], s15 offen offset:0 lds
    buffer_load_dwordx4 v178, s[20:23], s15 offen offset:1024 lds
    s_add_u32 m0, s45, 12288
    s_add_u32 s43, s43, 196608
    buffer_load_dwordx4 v174, s[24:27], s43 offen offset:0 lds
    buffer_load_dwordx4 v175, s[24:27], s43 offen offset:1024 lds
    buffer_load_dwordx4 v176, s[24:27], s43 offen offset:2048 lds
    s_add_u32 m0, s46, 4096
    s_add_u32 s15, s44, 128
    buffer_load_dwordx4 v177, s[20:23], s15 offen offset:0 lds
    buffer_load_dwordx4 v178, s[20:23], s15 offen offset:1024 lds
    s_add_u32 m0, s46, 6144
    s_add_u32 s15, s44, 20608
    buffer_load_dwordx4 v177, s[20:23], s15 offen offset:0 lds
    buffer_load_dwordx4 v178, s[20:23], s15 offen offset:1024 lds
    v_lshrrev_b32 v2, 4, v1
    v_bfe_u32 v3, v1, 2, 2
    v_lshl_add_u32 v3, v2, 3, v3
    v_mul_u32_u24 v3, 192, v3
    v_and_b32 v4, 3, v1
    v_lshl_add_u32 v3, v4, 3, v3
    v_and_b32 v4, 1, v2
    v_lshlrev_b32 v4, 5, v4
    v_sub_u32 v5, v3, v4
    v_add_u32 v5, 32, v5
    v_add_u32 v4, v3, v4
    s_add_u32 s40, s12, 0
    s_cmp_ge_u32 s40, 3
    s_cselect_b32 s15, 3, 0
    s_sub_u32 s40, s40, s15
    s_lshl_b32 s15, s40, 6
    v_add_u32 v168, s15, v4
    v_add_u32 v171, s15, v5
    s_add_u32 s41, s12, 1
    s_cmp_ge_u32 s41, 3
    s_cselect_b32 s15, 3, 0
    s_sub_u32 s41, s41, s15
    s_lshl_b32 s15, s41, 6
    v_add_u32 v169, s15, v4
    v_add_u32 v172, s15, v5
    s_add_u32 s42, s12, 2
    s_cmp_ge_u32 s42, 3
    s_cselect_b32 s15, 3, 0
    s_sub_u32 s42, s42, s15
    s_lshl_b32 s15, s42, 6
    v_add_u32 v170, s15, v4
    v_add_u32 v173, s15, v5
    v_and_b32 v3, 15, v1
    v_lshrrev_b32 v4, 1, v3
    v_xor_b32 v4, v4, v2
    v_lshlrev_b32 v4, 4, v4
    v_lshl_add_u32 v4, v3, 7, v4
    v_add_u32 v179, s46, v4
    v_xor_b32 v4, 64, v4
    v_add_u32 v180, s46, v4
    v_lshrrev_b32 v4, 3, v3
    v_and_b32 v3, 7, v3
    v_lshlrev_b32 v3, 3, v3
    v_lshl_add_u32 v11, v4, 7, v3
    s_mul_i32 s15, s12, 12
    s_mul_i32 s47, s15, 40960
    s_mul_i32 s16, s39, 160
    s_add_u32 s47, s47, s16
    s_mul_i32 s48, s38, 192
    s_add_u32 s48, s48, s15
    s_lshl_b32 s48, s48, 10
    s_add_u32 s48, s48, 12582912
    v_lshlrev_b32 v2, 3, v2
    s_waitcnt lgkmcnt(0)
    s_mul_i32 s16, s37, 192
    s_lshl_b32 s15, s40, 6
    s_add_u32 s15, s15, s16
    buffer_load_dwordx2 v[244:245], v2, s[28:31], s15 offen offset:0
    buffer_load_dwordx2 v[246:247], v2, s[28:31], s15 offen offset:32
    s_mul_i32 s16, s37, 192
    s_lshl_b32 s15, s41, 6
    s_add_u32 s15, s15, s16
    buffer_load_dwordx2 v[248:249], v2, s[28:31], s15 offen offset:0
    buffer_load_dwordx2 v[250:251], v2, s[28:31], s15 offen offset:32
    s_mul_i32 s16, s37, 192
    s_lshl_b32 s15, s42, 6
    s_add_u32 s15, s15, s16
    buffer_load_dwordx2 v[252:253], v2, s[28:31], s15 offen offset:0
    buffer_load_dwordx2 v[254:255], v2, s[28:31], s15 offen offset:32
    s_waitcnt lgkmcnt(0)
    s_mov_b32 exec_lo, 0xffffff00
    s_mov_b32 exec_hi, 0xff
    buffer_load_dword v182, v108, s[20:23], 0 offen
    s_mov_b32 exec_lo, 0xfffff000
    s_mov_b32 exec_hi, 0xfffffff
    buffer_load_dword v182, v109, s[24:27], 0 offen
    s_mov_b64 exec, -1
    s_waitcnt vmcnt(15)
    v_mov_b32 v164, 0x3f803f80
    v_mov_b32 v165, 0x3f803f80
    v_mov_b32 v166, 0x3f803f80
    v_mov_b32 v167, 0x3f803f80
    s_barrier
    ds_read_b128 v[132:135], v179 offset:0
    ds_read_b128 v[136:139], v179 offset:2048
    ds_read_b128 v[140:143], v180 offset:0
    ds_read_b128 v[144:147], v180 offset:2048
    ds_read_b64_tr_b16 v[84:85], v168 offset:0
    ds_read_b64_tr_b16 v[86:87], v168 offset:768
    ds_read_b64_tr_b16 v[88:89], v171 offset:0
    ds_read_b64_tr_b16 v[90:91], v171 offset:768
    ds_read_b64_tr_b16 v[92:93], v169 offset:0
    ds_read_b64_tr_b16 v[94:95], v169 offset:768
    ds_read_b64_tr_b16 v[96:97], v172 offset:0
    ds_read_b64_tr_b16 v[98:99], v172 offset:768
    ds_read_b64_tr_b16 v[100:101], v170 offset:0
    ds_read_b64_tr_b16 v[102:103], v170 offset:768
    ds_read_b64_tr_b16 v[104:105], v173 offset:0
    ds_read_b64_tr_b16 v[106:107], v173 offset:768
    s_add_u32 m0, s46, 8192
    s_add_u32 s15, s44, 256
    buffer_load_dwordx4 v177, s[20:23], s15 offen offset:0 lds
    buffer_load_dwordx4 v178, s[20:23], s15 offen offset:1024 lds
    s_add_u32 m0, s45, 24576
    s_add_u32 s43, s43, 196608
    buffer_load_dwordx4 v174, s[24:27], s43 offen offset:0 lds
    buffer_load_dwordx4 v175, s[24:27], s43 offen offset:1024 lds
    buffer_load_dwordx4 v176, s[24:27], s43 offen offset:2048 lds
    buffer_load_dword v7, v6, s[8:11], 0 offen sc1
    s_setprio 2
    s_waitcnt lgkmcnt(12)
    s_waitcnt lgkmcnt(10)
    v_mfma_f32_16x16x32_bf16 v[184:187], v[84:87], v[132:135], 0
    ds_read_b64_tr_b16 v[108:109], v168 offset:6144
    ds_read_b64_tr_b16 v[110:111], v168 offset:6912
    v_mfma_f32_16x16x32_bf16 v[188:191], v[84:87], v[136:139], 0
    s_add_u32 m0, s46, 0
    s_add_u32 s15, s44, 20736
    ds_read_b64_tr_b16 v[112:113], v171 offset:6144
    v_mfma_f32_16x16x32_bf16 v[232:235], v[84:87], v[164:167], 0
    ds_read_b64_tr_b16 v[114:115], v171 offset:6912
    buffer_load_dwordx4 v177, s[20:23], s15 offen offset:0 lds
    s_waitcnt lgkmcnt(12)
    v_mfma_f32_16x16x32_bf16 v[192:195], v[88:91], v[132:135], 0
    ds_read_b64_tr_b16 v[116:117], v169 offset:6144
    ds_read_b64_tr_b16 v[118:119], v169 offset:6912
    v_mfma_f32_16x16x32_bf16 v[196:199], v[88:91], v[136:139], 0
    buffer_load_dwordx4 v178, s[20:23], s15 offen offset:1024 lds
    v_mfma_f32_16x16x32_bf16 v[236:239], v[88:91], v[164:167], 0
    ds_read_b64_tr_b16 v[120:121], v172 offset:6144
    s_waitcnt lgkmcnt(13)
    v_mfma_f32_16x16x32_bf16 v[200:203], v[92:95], v[132:135], 0
    ds_read_b64_tr_b16 v[122:123], v172 offset:6912
    v_mfma_f32_16x16x32_bf16 v[204:207], v[92:95], v[136:139], 0
    s_add_u32 m0, s46, 2048
    s_add_u32 s15, s44, 384
    s_waitcnt lgkmcnt(12)
    v_mfma_f32_16x16x32_bf16 v[208:211], v[96:99], v[132:135], 0
    ds_read_b64_tr_b16 v[124:125], v170 offset:6144
    v_mfma_f32_16x16x32_bf16 v[212:215], v[96:99], v[136:139], 0
    ds_read_b64_tr_b16 v[126:127], v170 offset:6912
    s_waitcnt lgkmcnt(12)
    v_mfma_f32_16x16x32_bf16 v[216:219], v[100:103], v[132:135], 0
    buffer_load_dwordx4 v177, s[20:23], s15 offen offset:0 lds
    v_mfma_f32_16x16x32_bf16 v[220:223], v[100:103], v[136:139], 0
    ds_read_b64_tr_b16 v[128:129], v173 offset:6144
    s_waitcnt lgkmcnt(11)
    v_mfma_f32_16x16x32_bf16 v[224:227], v[104:107], v[132:135], 0
    ds_read_b64_tr_b16 v[130:131], v173 offset:6912
    v_mfma_f32_16x16x32_bf16 v[228:231], v[104:107], v[136:139], 0
    buffer_load_dwordx4 v178, s[20:23], s15 offen offset:1024 lds
    s_waitcnt lgkmcnt(10)
    v_mfma_f32_16x16x32_bf16 v[184:187], v[108:111], v[140:143], v[184:187]
    v_mfma_f32_16x16x32_bf16 v[188:191], v[108:111], v[144:147], v[188:191]
    v_mfma_f32_16x16x32_bf16 v[232:235], v[108:111], v[164:167], v[232:235]
    s_waitcnt lgkmcnt(8)
    v_mfma_f32_16x16x32_bf16 v[192:195], v[112:115], v[140:143], v[192:195]
    v_mfma_f32_16x16x32_bf16 v[196:199], v[112:115], v[144:147], v[196:199]
    v_mfma_f32_16x16x32_bf16 v[236:239], v[112:115], v[164:167], v[236:239]
    s_waitcnt vmcnt(18) lgkmcnt(0)
    s_barrier
    v_mfma_f32_16x16x32_bf16 v[200:203], v[116:119], v[140:143], v[200:203]
    ds_read_b128 v[148:151], v179 offset:4096
    ds_read_b128 v[152:155], v179 offset:6144
    ds_read_b128 v[156:159], v180 offset:4096
    v_mfma_f32_16x16x32_bf16 v[204:207], v[116:119], v[144:147], v[204:207]
    ds_read_b128 v[160:163], v180 offset:6144
    ds_read_b64_tr_b16 v[84:85], v168 offset:12288
    ds_read_b64_tr_b16 v[86:87], v168 offset:13056
    v_mfma_f32_16x16x32_bf16 v[208:211], v[120:123], v[140:143], v[208:211]
    ds_read_b64_tr_b16 v[88:89], v171 offset:12288
    ds_read_b64_tr_b16 v[90:91], v171 offset:13056
    ds_read_b64_tr_b16 v[92:93], v169 offset:12288
    v_mfma_f32_16x16x32_bf16 v[212:215], v[120:123], v[144:147], v[212:215]
    ds_read_b64_tr_b16 v[94:95], v169 offset:13056
    ds_read_b64_tr_b16 v[96:97], v172 offset:12288
    ds_read_b64_tr_b16 v[98:99], v172 offset:13056
    v_mfma_f32_16x16x32_bf16 v[216:219], v[124:127], v[140:143], v[216:219]
    ds_read_b64_tr_b16 v[100:101], v170 offset:12288
    ds_read_b64_tr_b16 v[102:103], v170 offset:13056
    v_mfma_f32_16x16x32_bf16 v[220:223], v[124:127], v[144:147], v[220:223]
    ds_read_b64_tr_b16 v[104:105], v173 offset:12288
    ds_read_b64_tr_b16 v[106:107], v173 offset:13056
    v_mfma_f32_16x16x32_bf16 v[224:227], v[128:131], v[140:143], v[224:227]
    s_add_u32 m0, s45, 0
    s_add_u32 s43, s43, 196608
    buffer_load_dwordx4 v174, s[24:27], s43 offen offset:0 lds
    v_mfma_f32_16x16x32_bf16 v[228:231], v[128:131], v[144:147], v[228:231]
    buffer_load_dwordx4 v175, s[24:27], s43 offen offset:1024 lds
    buffer_load_dwordx4 v176, s[24:27], s43 offen offset:2048 lds
    s_waitcnt lgkmcnt(12)
    s_waitcnt lgkmcnt(10)
    v_mfma_f32_16x16x32_bf16 v[184:187], v[84:87], v[148:151], v[184:187]
    ds_read_b64_tr_b16 v[108:109], v168 offset:18432
    ds_read_b64_tr_b16 v[110:111], v168 offset:19200
    v_mfma_f32_16x16x32_bf16 v[188:191], v[84:87], v[152:155], v[188:191]
    s_add_u32 m0, s46, 4096
    s_add_u32 s15, s44, 20864
    ds_read_b64_tr_b16 v[112:113], v171 offset:18432
    v_mfma_f32_16x16x32_bf16 v[232:235], v[84:87], v[164:167], v[232:235]
    ds_read_b64_tr_b16 v[114:115], v171 offset:19200
    buffer_load_dwordx4 v177, s[20:23], s15 offen offset:0 lds
    s_waitcnt lgkmcnt(12)
    v_mfma_f32_16x16x32_bf16 v[192:195], v[88:91], v[148:151], v[192:195]
    ds_read_b64_tr_b16 v[116:117], v169 offset:18432
    ds_read_b64_tr_b16 v[118:119], v169 offset:19200
    v_mfma_f32_16x16x32_bf16 v[196:199], v[88:91], v[152:155], v[196:199]
    buffer_load_dwordx4 v178, s[20:23], s15 offen offset:1024 lds
    v_mfma_f32_16x16x32_bf16 v[236:239], v[88:91], v[164:167], v[236:239]
    ds_read_b64_tr_b16 v[120:121], v172 offset:18432
    s_waitcnt lgkmcnt(13)
    v_mfma_f32_16x16x32_bf16 v[200:203], v[92:95], v[148:151], v[200:203]
    ds_read_b64_tr_b16 v[122:123], v172 offset:19200
    v_mfma_f32_16x16x32_bf16 v[204:207], v[92:95], v[152:155], v[204:207]
    s_add_u32 m0, s46, 6144
    s_add_u32 s15, s44, 512
    s_waitcnt lgkmcnt(12)
    v_mfma_f32_16x16x32_bf16 v[208:211], v[96:99], v[148:151], v[208:211]
    ds_read_b64_tr_b16 v[124:125], v170 offset:18432
    v_mfma_f32_16x16x32_bf16 v[212:215], v[96:99], v[152:155], v[212:215]
    ds_read_b64_tr_b16 v[126:127], v170 offset:19200
    s_waitcnt lgkmcnt(12)
    v_mfma_f32_16x16x32_bf16 v[216:219], v[100:103], v[148:151], v[216:219]
    buffer_load_dwordx4 v177, s[20:23], s15 offen offset:0 lds
    v_mfma_f32_16x16x32_bf16 v[220:223], v[100:103], v[152:155], v[220:223]
    ds_read_b64_tr_b16 v[128:129], v173 offset:18432
    s_waitcnt lgkmcnt(11)
    v_mfma_f32_16x16x32_bf16 v[224:227], v[104:107], v[148:151], v[224:227]
    ds_read_b64_tr_b16 v[130:131], v173 offset:19200
    v_mfma_f32_16x16x32_bf16 v[228:231], v[104:107], v[152:155], v[228:231]
    buffer_load_dwordx4 v178, s[20:23], s15 offen offset:1024 lds
    s_waitcnt lgkmcnt(10)
    v_mfma_f32_16x16x32_bf16 v[184:187], v[108:111], v[156:159], v[184:187]
    v_mfma_f32_16x16x32_bf16 v[188:191], v[108:111], v[160:163], v[188:191]
    v_mfma_f32_16x16x32_bf16 v[232:235], v[108:111], v[164:167], v[232:235]
    s_waitcnt lgkmcnt(8)
    v_mfma_f32_16x16x32_bf16 v[192:195], v[112:115], v[156:159], v[192:195]
    v_mfma_f32_16x16x32_bf16 v[196:199], v[112:115], v[160:163], v[196:199]
    v_mfma_f32_16x16x32_bf16 v[236:239], v[112:115], v[164:167], v[236:239]
    s_waitcnt vmcnt(9) lgkmcnt(0)
    s_barrier
    v_mfma_f32_16x16x32_bf16 v[200:203], v[116:119], v[156:159], v[200:203]
    ds_read_b128 v[132:135], v179 offset:8192
    ds_read_b128 v[136:139], v179 offset:0
    ds_read_b128 v[140:143], v180 offset:8192
    v_mfma_f32_16x16x32_bf16 v[204:207], v[116:119], v[160:163], v[204:207]
    ds_read_b128 v[144:147], v180 offset:0
    ds_read_b64_tr_b16 v[84:85], v168 offset:24576
    ds_read_b64_tr_b16 v[86:87], v168 offset:25344
    v_mfma_f32_16x16x32_bf16 v[208:211], v[120:123], v[156:159], v[208:211]
    ds_read_b64_tr_b16 v[88:89], v171 offset:24576
    ds_read_b64_tr_b16 v[90:91], v171 offset:25344
    ds_read_b64_tr_b16 v[92:93], v169 offset:24576
    v_mfma_f32_16x16x32_bf16 v[212:215], v[120:123], v[160:163], v[212:215]
    ds_read_b64_tr_b16 v[94:95], v169 offset:25344
    ds_read_b64_tr_b16 v[96:97], v172 offset:24576
    ds_read_b64_tr_b16 v[98:99], v172 offset:25344
    v_mfma_f32_16x16x32_bf16 v[216:219], v[124:127], v[156:159], v[216:219]
    ds_read_b64_tr_b16 v[100:101], v170 offset:24576
    ds_read_b64_tr_b16 v[102:103], v170 offset:25344
    v_mfma_f32_16x16x32_bf16 v[220:223], v[124:127], v[160:163], v[220:223]
    ds_read_b64_tr_b16 v[104:105], v173 offset:24576
    ds_read_b64_tr_b16 v[106:107], v173 offset:25344
    v_mfma_f32_16x16x32_bf16 v[224:227], v[128:131], v[156:159], v[224:227]
    s_add_u32 m0, s45, 12288
    s_add_u32 s43, s43, 196608
    buffer_load_dwordx4 v174, s[24:27], s43 offen offset:0 lds
    v_mfma_f32_16x16x32_bf16 v[228:231], v[128:131], v[160:163], v[228:231]
    buffer_load_dwordx4 v175, s[24:27], s43 offen offset:1024 lds
    buffer_load_dwordx4 v176, s[24:27], s43 offen offset:2048 lds
    s_waitcnt lgkmcnt(12)
    s_waitcnt lgkmcnt(10)
    v_mfma_f32_16x16x32_bf16 v[184:187], v[84:87], v[132:135], v[184:187]
    ds_read_b64_tr_b16 v[108:109], v168 offset:30720
    ds_read_b64_tr_b16 v[110:111], v168 offset:31488
    v_mfma_f32_16x16x32_bf16 v[188:191], v[84:87], v[136:139], v[188:191]
    s_add_u32 m0, s46, 8192
    s_add_u32 s15, s44, 20992
    ds_read_b64_tr_b16 v[112:113], v171 offset:30720
    v_mfma_f32_16x16x32_bf16 v[232:235], v[84:87], v[164:167], v[232:235]
    ds_read_b64_tr_b16 v[114:115], v171 offset:31488
    buffer_load_dwordx4 v177, s[20:23], s15 offen offset:0 lds
    s_waitcnt lgkmcnt(12)
    v_mfma_f32_16x16x32_bf16 v[192:195], v[88:91], v[132:135], v[192:195]
    ds_read_b64_tr_b16 v[116:117], v169 offset:30720
    ds_read_b64_tr_b16 v[118:119], v169 offset:31488
    v_mfma_f32_16x16x32_bf16 v[196:199], v[88:91], v[136:139], v[196:199]
    buffer_load_dwordx4 v178, s[20:23], s15 offen offset:1024 lds
    ds_read_b64_tr_b16 v[120:121], v172 offset:30720
    v_mfma_f32_16x16x32_bf16 v[236:239], v[88:91], v[164:167], v[236:239]
    ds_read_b64_tr_b16 v[122:123], v172 offset:31488
    s_waitcnt lgkmcnt(14)
    v_mfma_f32_16x16x32_bf16 v[200:203], v[92:95], v[132:135], v[200:203]
    s_add_u32 m0, s46, 0
    s_add_u32 s15, s44, 640
    v_mfma_f32_16x16x32_bf16 v[204:207], v[92:95], v[136:139], v[204:207]
    ds_read_b64_tr_b16 v[124:125], v170 offset:30720
    s_waitcnt lgkmcnt(13)
    v_mfma_f32_16x16x32_bf16 v[208:211], v[96:99], v[132:135], v[208:211]
    ds_read_b64_tr_b16 v[126:127], v170 offset:31488
    v_mfma_f32_16x16x32_bf16 v[212:215], v[96:99], v[136:139], v[212:215]
    buffer_load_dwordx4 v177, s[20:23], s15 offen offset:0 lds
    s_waitcnt lgkmcnt(12)
    v_mfma_f32_16x16x32_bf16 v[216:219], v[100:103], v[132:135], v[216:219]
    ds_read_b64_tr_b16 v[128:129], v173 offset:30720
    v_mfma_f32_16x16x32_bf16 v[220:223], v[100:103], v[136:139], v[220:223]
    ds_read_b64_tr_b16 v[130:131], v173 offset:31488
    s_waitcnt lgkmcnt(12)
    v_mfma_f32_16x16x32_bf16 v[224:227], v[104:107], v[132:135], v[224:227]
    buffer_load_dwordx4 v178, s[20:23], s15 offen offset:1024 lds
    v_mfma_f32_16x16x32_bf16 v[228:231], v[104:107], v[136:139], v[228:231]
    s_add_u32 s16, s3, 0
    s_and_b32 s16, s16, 7
    s_mul_i32 s16, s16, 245760
    s_mov_b64 exec, 0x7fff
    buffer_load_dword v182, v181, s[52:55], s16 offen
    s_mov_b64 exec, -1
    s_waitcnt lgkmcnt(10)
    v_mfma_f32_16x16x32_bf16 v[184:187], v[108:111], v[140:143], v[184:187]
    v_mfma_f32_16x16x32_bf16 v[188:191], v[108:111], v[144:147], v[188:191]
    v_mfma_f32_16x16x32_bf16 v[232:235], v[108:111], v[164:167], v[232:235]
    s_waitcnt lgkmcnt(8)
    v_mfma_f32_16x16x32_bf16 v[192:195], v[112:115], v[140:143], v[192:195]
    v_mfma_f32_16x16x32_bf16 v[196:199], v[112:115], v[144:147], v[196:199]
    v_mfma_f32_16x16x32_bf16 v[236:239], v[112:115], v[164:167], v[236:239]
    s_waitcnt vmcnt(10) lgkmcnt(0)
    s_barrier
    v_mfma_f32_16x16x32_bf16 v[200:203], v[116:119], v[140:143], v[200:203]
    ds_read_b128 v[148:151], v179 offset:2048
    ds_read_b128 v[152:155], v179 offset:4096
    ds_read_b128 v[156:159], v180 offset:2048
    v_mfma_f32_16x16x32_bf16 v[204:207], v[116:119], v[144:147], v[204:207]
    ds_read_b128 v[160:163], v180 offset:4096
    ds_read_b64_tr_b16 v[84:85], v168 offset:0
    ds_read_b64_tr_b16 v[86:87], v168 offset:768
    v_mfma_f32_16x16x32_bf16 v[208:211], v[120:123], v[140:143], v[208:211]
    ds_read_b64_tr_b16 v[88:89], v171 offset:0
    ds_read_b64_tr_b16 v[90:91], v171 offset:768
    ds_read_b64_tr_b16 v[92:93], v169 offset:0
    v_mfma_f32_16x16x32_bf16 v[212:215], v[120:123], v[144:147], v[212:215]
    ds_read_b64_tr_b16 v[94:95], v169 offset:768
    ds_read_b64_tr_b16 v[96:97], v172 offset:0
    ds_read_b64_tr_b16 v[98:99], v172 offset:768
    v_mfma_f32_16x16x32_bf16 v[216:219], v[124:127], v[140:143], v[216:219]
    ds_read_b64_tr_b16 v[100:101], v170 offset:0
    ds_read_b64_tr_b16 v[102:103], v170 offset:768
    v_mfma_f32_16x16x32_bf16 v[220:223], v[124:127], v[144:147], v[220:223]
    ds_read_b64_tr_b16 v[104:105], v173 offset:0
    ds_read_b64_tr_b16 v[106:107], v173 offset:768
    v_mfma_f32_16x16x32_bf16 v[224:227], v[128:131], v[140:143], v[224:227]
    s_add_u32 m0, s45, 24576
    s_add_u32 s43, s43, 196608
    buffer_load_dwordx4 v174, s[24:27], s43 offen offset:0 lds
    v_mfma_f32_16x16x32_bf16 v[228:231], v[128:131], v[144:147], v[228:231]
    buffer_load_dwordx4 v175, s[24:27], s43 offen offset:1024 lds
    buffer_load_dwordx4 v176, s[24:27], s43 offen offset:2048 lds
    s_waitcnt lgkmcnt(12)
    s_waitcnt lgkmcnt(10)
    v_mfma_f32_16x16x32_bf16 v[184:187], v[84:87], v[148:151], v[184:187]
    ds_read_b64_tr_b16 v[108:109], v168 offset:6144
    ds_read_b64_tr_b16 v[110:111], v168 offset:6912
    v_mfma_f32_16x16x32_bf16 v[188:191], v[84:87], v[152:155], v[188:191]
    s_add_u32 m0, s46, 2048
    s_add_u32 s15, s44, 21120
    ds_read_b64_tr_b16 v[112:113], v171 offset:6144
    v_mfma_f32_16x16x32_bf16 v[232:235], v[84:87], v[164:167], v[232:235]
    ds_read_b64_tr_b16 v[114:115], v171 offset:6912
    buffer_load_dwordx4 v177, s[20:23], s15 offen offset:0 lds
    s_waitcnt lgkmcnt(12)
    v_mfma_f32_16x16x32_bf16 v[192:195], v[88:91], v[148:151], v[192:195]
    ds_read_b64_tr_b16 v[116:117], v169 offset:6144
    ds_read_b64_tr_b16 v[118:119], v169 offset:6912
    v_mfma_f32_16x16x32_bf16 v[196:199], v[88:91], v[152:155], v[196:199]
    buffer_load_dwordx4 v178, s[20:23], s15 offen offset:1024 lds
    v_mfma_f32_16x16x32_bf16 v[236:239], v[88:91], v[164:167], v[236:239]
    ds_read_b64_tr_b16 v[120:121], v172 offset:6144
    s_waitcnt lgkmcnt(13)
    v_mfma_f32_16x16x32_bf16 v[200:203], v[92:95], v[148:151], v[200:203]
    ds_read_b64_tr_b16 v[122:123], v172 offset:6912
    v_mfma_f32_16x16x32_bf16 v[204:207], v[92:95], v[152:155], v[204:207]
    s_add_u32 m0, s46, 4096
    s_add_u32 s15, s44, 768
    s_waitcnt lgkmcnt(12)
    v_mfma_f32_16x16x32_bf16 v[208:211], v[96:99], v[148:151], v[208:211]
    ds_read_b64_tr_b16 v[124:125], v170 offset:6144
    v_mfma_f32_16x16x32_bf16 v[212:215], v[96:99], v[152:155], v[212:215]
    ds_read_b64_tr_b16 v[126:127], v170 offset:6912
    s_waitcnt lgkmcnt(12)
    v_mfma_f32_16x16x32_bf16 v[216:219], v[100:103], v[148:151], v[216:219]
    buffer_load_dwordx4 v177, s[20:23], s15 offen offset:0 lds
    v_mfma_f32_16x16x32_bf16 v[220:223], v[100:103], v[152:155], v[220:223]
    ds_read_b64_tr_b16 v[128:129], v173 offset:6144
    s_waitcnt lgkmcnt(11)
    v_mfma_f32_16x16x32_bf16 v[224:227], v[104:107], v[148:151], v[224:227]
    ds_read_b64_tr_b16 v[130:131], v173 offset:6912
    v_mfma_f32_16x16x32_bf16 v[228:231], v[104:107], v[152:155], v[228:231]
    buffer_load_dwordx4 v178, s[20:23], s15 offen offset:1024 lds
    s_waitcnt lgkmcnt(10)
    v_mfma_f32_16x16x32_bf16 v[184:187], v[108:111], v[156:159], v[184:187]
    v_mfma_f32_16x16x32_bf16 v[188:191], v[108:111], v[160:163], v[188:191]
    v_mfma_f32_16x16x32_bf16 v[232:235], v[108:111], v[164:167], v[232:235]
    s_waitcnt lgkmcnt(8)
    v_mfma_f32_16x16x32_bf16 v[192:195], v[112:115], v[156:159], v[192:195]
    v_mfma_f32_16x16x32_bf16 v[196:199], v[112:115], v[160:163], v[196:199]
    v_mfma_f32_16x16x32_bf16 v[236:239], v[112:115], v[164:167], v[236:239]
    s_waitcnt vmcnt(10) lgkmcnt(0)
    s_barrier
    v_mfma_f32_16x16x32_bf16 v[200:203], v[116:119], v[156:159], v[200:203]
    ds_read_b128 v[132:135], v179 offset:6144
    ds_read_b128 v[136:139], v179 offset:8192
    ds_read_b128 v[140:143], v180 offset:6144
    v_mfma_f32_16x16x32_bf16 v[204:207], v[116:119], v[160:163], v[204:207]
    ds_read_b128 v[144:147], v180 offset:8192
    ds_read_b64_tr_b16 v[84:85], v168 offset:12288
    ds_read_b64_tr_b16 v[86:87], v168 offset:13056
    v_mfma_f32_16x16x32_bf16 v[208:211], v[120:123], v[156:159], v[208:211]
    ds_read_b64_tr_b16 v[88:89], v171 offset:12288
    ds_read_b64_tr_b16 v[90:91], v171 offset:13056
    ds_read_b64_tr_b16 v[92:93], v169 offset:12288
    v_mfma_f32_16x16x32_bf16 v[212:215], v[120:123], v[160:163], v[212:215]
    ds_read_b64_tr_b16 v[94:95], v169 offset:13056
    ds_read_b64_tr_b16 v[96:97], v172 offset:12288
    ds_read_b64_tr_b16 v[98:99], v172 offset:13056
    v_mfma_f32_16x16x32_bf16 v[216:219], v[124:127], v[156:159], v[216:219]
    ds_read_b64_tr_b16 v[100:101], v170 offset:12288
    ds_read_b64_tr_b16 v[102:103], v170 offset:13056
    v_mfma_f32_16x16x32_bf16 v[220:223], v[124:127], v[160:163], v[220:223]
    ds_read_b64_tr_b16 v[104:105], v173 offset:12288
    ds_read_b64_tr_b16 v[106:107], v173 offset:13056
    v_mfma_f32_16x16x32_bf16 v[224:227], v[128:131], v[156:159], v[224:227]
    s_add_u32 m0, s45, 0
    s_add_u32 s43, s43, 196608
    buffer_load_dwordx4 v174, s[24:27], s43 offen offset:0 lds
    v_mfma_f32_16x16x32_bf16 v[228:231], v[128:131], v[160:163], v[228:231]
    buffer_load_dwordx4 v175, s[24:27], s43 offen offset:1024 lds
    buffer_load_dwordx4 v176, s[24:27], s43 offen offset:2048 lds
    s_waitcnt lgkmcnt(12)
    s_waitcnt lgkmcnt(10)
    v_mfma_f32_16x16x32_bf16 v[184:187], v[84:87], v[132:135], v[184:187]
    ds_read_b64_tr_b16 v[108:109], v168 offset:18432
    ds_read_b64_tr_b16 v[110:111], v168 offset:19200
    v_mfma_f32_16x16x32_bf16 v[188:191], v[84:87], v[136:139], v[188:191]
    s_add_u32 m0, s46, 6144
    s_add_u32 s15, s44, 21248
    ds_read_b64_tr_b16 v[112:113], v171 offset:18432
    v_mfma_f32_16x16x32_bf16 v[232:235], v[84:87], v[164:167], v[232:235]
    ds_read_b64_tr_b16 v[114:115], v171 offset:19200
    buffer_load_dwordx4 v177, s[20:23], s15 offen offset:0 lds
    s_waitcnt lgkmcnt(12)
    v_mfma_f32_16x16x32_bf16 v[192:195], v[88:91], v[132:135], v[192:195]
    ds_read_b64_tr_b16 v[116:117], v169 offset:18432
    ds_read_b64_tr_b16 v[118:119], v169 offset:19200
    v_mfma_f32_16x16x32_bf16 v[196:199], v[88:91], v[136:139], v[196:199]
    buffer_load_dwordx4 v178, s[20:23], s15 offen offset:1024 lds
    v_mfma_f32_16x16x32_bf16 v[236:239], v[88:91], v[164:167], v[236:239]
    ds_read_b64_tr_b16 v[120:121], v172 offset:18432
    s_waitcnt lgkmcnt(13)
    v_mfma_f32_16x16x32_bf16 v[200:203], v[92:95], v[132:135], v[200:203]
    ds_read_b64_tr_b16 v[122:123], v172 offset:19200
    v_mfma_f32_16x16x32_bf16 v[204:207], v[92:95], v[136:139], v[204:207]
    s_add_u32 m0, s46, 8192
    s_add_u32 s15, s44, 896
    s_waitcnt lgkmcnt(12)
    v_mfma_f32_16x16x32_bf16 v[208:211], v[96:99], v[132:135], v[208:211]
    ds_read_b64_tr_b16 v[124:125], v170 offset:18432
    v_mfma_f32_16x16x32_bf16 v[212:215], v[96:99], v[136:139], v[212:215]
    ds_read_b64_tr_b16 v[126:127], v170 offset:19200
    s_waitcnt lgkmcnt(12)
    v_mfma_f32_16x16x32_bf16 v[216:219], v[100:103], v[132:135], v[216:219]
    buffer_load_dwordx4 v177, s[20:23], s15 offen offset:0 lds
    v_mfma_f32_16x16x32_bf16 v[220:223], v[100:103], v[136:139], v[220:223]
    ds_read_b64_tr_b16 v[128:129], v173 offset:18432
    s_waitcnt lgkmcnt(11)
    v_mfma_f32_16x16x32_bf16 v[224:227], v[104:107], v[132:135], v[224:227]
    ds_read_b64_tr_b16 v[130:131], v173 offset:19200
    v_mfma_f32_16x16x32_bf16 v[228:231], v[104:107], v[136:139], v[228:231]
    buffer_load_dwordx4 v178, s[20:23], s15 offen offset:1024 lds
    s_waitcnt lgkmcnt(10)
    v_mfma_f32_16x16x32_bf16 v[184:187], v[108:111], v[140:143], v[184:187]
    v_mfma_f32_16x16x32_bf16 v[188:191], v[108:111], v[144:147], v[188:191]
    v_mfma_f32_16x16x32_bf16 v[232:235], v[108:111], v[164:167], v[232:235]
    s_waitcnt lgkmcnt(8)
    v_mfma_f32_16x16x32_bf16 v[192:195], v[112:115], v[140:143], v[192:195]
    v_mfma_f32_16x16x32_bf16 v[196:199], v[112:115], v[144:147], v[196:199]
    v_mfma_f32_16x16x32_bf16 v[236:239], v[112:115], v[164:167], v[236:239]
    s_waitcnt vmcnt(9) lgkmcnt(0)
    s_barrier
    v_mfma_f32_16x16x32_bf16 v[200:203], v[116:119], v[140:143], v[200:203]
    ds_read_b128 v[148:151], v179 offset:0
    ds_read_b128 v[152:155], v179 offset:2048
    ds_read_b128 v[156:159], v180 offset:0
    v_mfma_f32_16x16x32_bf16 v[204:207], v[116:119], v[144:147], v[204:207]
    ds_read_b128 v[160:163], v180 offset:2048
    ds_read_b64_tr_b16 v[84:85], v168 offset:24576
    ds_read_b64_tr_b16 v[86:87], v168 offset:25344
    v_mfma_f32_16x16x32_bf16 v[208:211], v[120:123], v[140:143], v[208:211]
    ds_read_b64_tr_b16 v[88:89], v171 offset:24576
    ds_read_b64_tr_b16 v[90:91], v171 offset:25344
    ds_read_b64_tr_b16 v[92:93], v169 offset:24576
    v_mfma_f32_16x16x32_bf16 v[212:215], v[120:123], v[144:147], v[212:215]
    ds_read_b64_tr_b16 v[94:95], v169 offset:25344
    ds_read_b64_tr_b16 v[96:97], v172 offset:24576
    ds_read_b64_tr_b16 v[98:99], v172 offset:25344
    v_mfma_f32_16x16x32_bf16 v[216:219], v[124:127], v[140:143], v[216:219]
    ds_read_b64_tr_b16 v[100:101], v170 offset:24576
    ds_read_b64_tr_b16 v[102:103], v170 offset:25344
    ds_read_b64_tr_b16 v[104:105], v173 offset:24576
    v_mfma_f32_16x16x32_bf16 v[220:223], v[124:127], v[144:147], v[220:223]
    ds_read_b64_tr_b16 v[106:107], v173 offset:25344
    s_add_u32 m0, s45, 12288
    s_add_u32 s43, s43, 196608
    v_mfma_f32_16x16x32_bf16 v[224:227], v[128:131], v[140:143], v[224:227]
    buffer_load_dwordx4 v174, s[24:27], s43 offen offset:0 lds
    buffer_load_dwordx4 v175, s[24:27], s43 offen offset:1024 lds
    v_mfma_f32_16x16x32_bf16 v[228:231], v[128:131], v[144:147], v[228:231]
    buffer_load_dwordx4 v176, s[24:27], s43 offen offset:2048 lds
    s_waitcnt vmcnt(36)
    v_readfirstlane_b32 s13, v7
    s_nop 0
    s_cmp_lg_u32 s13, 0
    s_cbranch_scc1 TK_1
    s_mov_b32 s14, 0
TL_2:
    s_sleep 2
    buffer_load_dword v7, v6, s[8:11], 0 offen sc1
    s_waitcnt vmcnt(0)
    v_readfirstlane_b32 s13, v7
    s_nop 0
    s_cmp_lg_u32 s13, 0
    s_cbranch_scc1 TK_1
    s_add_u32 s14, s14, 1
    s_cmp_lt_u32 s14, 16384
    s_cbranch_scc1 TL_2
TK_1:
    s_waitcnt lgkmcnt(12)
    s_waitcnt lgkmcnt(10)
    v_mfma_f32_16x16x32_bf16 v[184:187], v[84:87], v[148:151], v[184:187]
    ds_read_b64_tr_b16 v[108:109], v168 offset:30720
    ds_read_b64_tr_b16 v[110:111], v168 offset:31488
    v_mfma_f32_16x16x32_bf16 v[188:191], v[84:87], v[152:155], v[188:191]
    s_add_u32 m0, s46, 0
    s_add_u32 s15, s44, 21376
    ds_read_b64_tr_b16 v[112:113], v171 offset:30720
    v_mfma_f32_16x16x32_bf16 v[232:235], v[84:87], v[164:167], v[232:235]
    ds_read_b64_tr_b16 v[114:115], v171 offset:31488
    buffer_load_dwordx4 v177, s[20:23], s15 offen offset:0 lds
    s_waitcnt lgkmcnt(12)
    v_mfma_f32_16x16x32_bf16 v[192:195], v[88:91], v[148:151], v[192:195]
    ds_read_b64_tr_b16 v[116:117], v169 offset:30720
    ds_read_b64_tr_b16 v[118:119], v169 offset:31488
    v_mfma_f32_16x16x32_bf16 v[196:199], v[88:91], v[152:155], v[196:199]
    buffer_load_dwordx4 v178, s[20:23], s15 offen offset:1024 lds
    v_mfma_f32_16x16x32_bf16 v[236:239], v[88:91], v[164:167], v[236:239]
    ds_read_b64_tr_b16 v[120:121], v172 offset:30720
    s_waitcnt lgkmcnt(13)
    v_mfma_f32_16x16x32_bf16 v[200:203], v[92:95], v[148:151], v[200:203]
    ds_read_b64_tr_b16 v[122:123], v172 offset:31488
    v_mfma_f32_16x16x32_bf16 v[204:207], v[92:95], v[152:155], v[204:207]
    s_add_u32 m0, s46, 2048
    s_add_u32 s15, s44, 1024
    s_waitcnt lgkmcnt(12)
    v_mfma_f32_16x16x32_bf16 v[208:211], v[96:99], v[148:151], v[208:211]
    ds_read_b64_tr_b16 v[124:125], v170 offset:30720
    v_mfma_f32_16x16x32_bf16 v[212:215], v[96:99], v[152:155], v[212:215]
    ds_read_b64_tr_b16 v[126:127], v170 offset:31488
    s_waitcnt lgkmcnt(12)
    v_mfma_f32_16x16x32_bf16 v[216:219], v[100:103], v[148:151], v[216:219]
    buffer_load_dwordx4 v177, s[20:23], s15 offen offset:0 lds
    v_mfma_f32_16x16x32_bf16 v[220:223], v[100:103], v[152:155], v[220:223]
    ds_read_b64_tr_b16 v[128:129], v173 offset:30720
    s_waitcnt lgkmcnt(11)
    v_mfma_f32_16x16x32_bf16 v[224:227], v[104:107], v[148:151], v[224:227]
    ds_read_b64_tr_b16 v[130:131], v173 offset:31488
    v_mfma_f32_16x16x32_bf16 v[228:231], v[104:107], v[152:155], v[228:231]
    buffer_load_dwordx4 v178, s[20:23], s15 offen offset:1024 lds
    s_waitcnt lgkmcnt(10)
    v_mfma_f32_16x16x32_bf16 v[184:187], v[108:111], v[156:159], v[184:187]
    v_mfma_f32_16x16x32_bf16 v[188:191], v[108:111], v[160:163], v[188:191]
    v_mfma_f32_16x16x32_bf16 v[232:235], v[108:111], v[164:167], v[232:235]
    s_waitcnt lgkmcnt(8)
    v_mfma_f32_16x16x32_bf16 v[192:195], v[112:115], v[156:159], v[192:195]
    v_mfma_f32_16x16x32_bf16 v[196:199], v[112:115], v[160:163], v[196:199]
    v_mfma_f32_16x16x32_bf16 v[236:239], v[112:115], v[164:167], v[236:239]
    s_waitcnt vmcnt(9) lgkmcnt(0)
    s_barrier
    v_mfma_f32_16x16x32_bf16 v[200:203], v[116:119], v[156:159], v[200:203]
    ds_read_b128 v[132:135], v179 offset:4096
    ds_read_b128 v[136:139], v179 offset:6144
    ds_read_b128 v[140:143], v180 offset:4096
    v_mfma_f32_16x16x32_bf16 v[204:207], v[116:119], v[160:163], v[204:207]
    ds_read_b128 v[144:147], v180 offset:6144
    ds_read_b64_tr_b16 v[84:85], v168 offset:0
    ds_read_b64_tr_b16 v[86:87], v168 offset:768
    v_mfma_f32_16x16x32_bf16 v[208:211], v[120:123], v[156:159], v[208:211]
    ds_read_b64_tr_b16 v[88:89], v171 offset:0
    ds_read_b64_tr_b16 v[90:91], v171 offset:768
    ds_read_b64_tr_b16 v[92:93], v169 offset:0
    v_mfma_f32_16x16x32_bf16 v[212:215], v[120:123], v[160:163], v[212:215]
    ds_read_b64_tr_b16 v[94:95], v169 offset:768
    ds_read_b64_tr_b16 v[96:97], v172 offset:0
    ds_read_b64_tr_b16 v[98:99], v172 offset:768
    v_mfma_f32_16x16x32_bf16 v[216:219], v[124:127], v[156:159], v[216:219]
    ds_read_b64_tr_b16 v[100:101], v170 offset:0
    ds_read_b64_tr_b16 v[102:103], v170 offset:768
    ds_read_b64_tr_b16 v[104:105], v173 offset:0
    v_mfma_f32_16x16x32_bf16 v[220:223], v[124:127], v[160:163], v[220:223]
    ds_read_b64_tr_b16 v[106:107], v173 offset:768
    s_add_u32 m0, s45, 24576
    s_add_u32 s43, s43, 196608
    v_mfma_f32_16x16x32_bf16 v[224:227], v[128:131], v[156:159], v[224:227]
    buffer_load_dwordx4 v174, s[24:27], s43 offen offset:0 lds
    buffer_load_dwordx4 v175, s[24:27], s43 offen offset:1024 lds
    v_mfma_f32_16x16x32_bf16 v[228:231], v[128:131], v[160:163], v[228:231]
    buffer_load_dwordx4 v176, s[24:27], s43 offen offset:2048 lds
    s_add_u32 s16, s3, 1
    s_and_b32 s16, s16, 7
    s_mul_i32 s16, s16, 245760
    s_mov_b64 exec, 0x7fff
    buffer_load_dword v182, v181, s[52:55], s16 offen
    s_mov_b64 exec, -1
    s_waitcnt lgkmcnt(12)
    s_waitcnt lgkmcnt(10)
    v_mfma_f32_16x16x32_bf16 v[184:187], v[84:87], v[132:135], v[184:187]
    ds_read_b64_tr_b16 v[108:109], v168 offset:6144
    ds_read_b64_tr_b16 v[110:111], v168 offset:6912
    v_mfma_f32_16x16x32_bf16 v[188:191], v[84:87], v[136:139], v[188:191]
    s_add_u32 m0, s46, 4096
    s_add_u32 s15, s44, 21504
    ds_read_b64_tr_b16 v[112:113], v171 offset:6144
    v_mfma_f32_16x16x32_bf16 v[232:235], v[84:87], v[164:167], v[232:235]
    ds_read_b64_tr_b16 v[114:115], v171 offset:6912
    buffer_load_dwordx4 v177, s[20:23], s15 offen offset:0 lds
    s_waitcnt lgkmcnt(12)
    v_mfma_f32_16x16x32_bf16 v[192:195], v[88:91], v[132:135], v[192:195]
    ds_read_b64_tr_b16 v[116:117], v169 offset:6144
    ds_read_b64_tr_b16 v[118:119], v169 offset:6912
    v_mfma_f32_16x16x32_bf16 v[196:199], v[88:91], v[136:139], v[196:199]
    buffer_load_dwordx4 v178, s[20:23], s15 offen offset:1024 lds
    ds_read_b64_tr_b16 v[120:121], v172 offset:6144
    v_mfma_f32_16x16x32_bf16 v[236:239], v[88:91], v[164:167], v[236:239]
    ds_read_b64_tr_b16 v[122:123], v172 offset:6912
    s_waitcnt lgkmcnt(14)
    v_mfma_f32_16x16x32_bf16 v[200:203], v[92:95], v[132:135], v[200:203]
    s_add_u32 m0, s46, 6144
    s_add_u32 s15, s44, 1152
    v_mfma_f32_16x16x32_bf16 v[204:207], v[92:95], v[136:139], v[204:207]
    ds_read_b64_tr_b16 v[124:125], v170 offset:6144
    s_waitcnt lgkmcnt(13)
    v_mfma_f32_16x16x32_bf16 v[208:211], v[96:99], v[132:135], v[208:211]
    ds_read_b64_tr_b16 v[126:127], v170 offset:6912
    v_mfma_f32_16x16x32_bf16 v[212:215], v[96:99], v[136:139], v[212:215]
    buffer_load_dwordx4 v177, s[20:23], s15 offen offset:0 lds
    s_waitcnt lgkmcnt(12)
    v_mfma_f32_16x16x32_bf16 v[216:219], v[100:103], v[132:135], v[216:219]
    ds_read_b64_tr_b16 v[128:129], v173 offset:6144
    v_mfma_f32_16x16x32_bf16 v[220:223], v[100:103], v[136:139], v[220:223]
    ds_read_b64_tr_b16 v[130:131], v173 offset:6912
    s_waitcnt lgkmcnt(12)
    v_mfma_f32_16x16x32_bf16 v[224:227], v[104:107], v[132:135], v[224:227]
    buffer_load_dwordx4 v178, s[20:23], s15 offen offset:1024 lds
    v_mfma_f32_16x16x32_bf16 v[228:231], v[104:107], v[136:139], v[228:231]
    s_add_u32 s16, s3, 2
    s_and_b32 s16, s16, 7
    s_mul_i32 s16, s16, 245760
    s_mov_b64 exec, 0x7fff
    buffer_load_dword v182, v181, s[52:55], s16 offen
    s_mov_b64 exec, -1
    s_waitcnt lgkmcnt(10)
    v_mfma_f32_16x16x32_bf16 v[184:187], v[108:111], v[140:143], v[184:187]
    v_mfma_f32_16x16x32_bf16 v[188:191], v[108:111], v[144:147], v[188:191]
    v_mfma_f32_16x16x32_bf16 v[232:235], v[108:111], v[164:167], v[232:235]
    s_waitcnt lgkmcnt(8)
    v_mfma_f32_16x16x32_bf16 v[192:195], v[112:115], v[140:143], v[192:195]
    v_mfma_f32_16x16x32_bf16 v[196:199], v[112:115], v[144:147], v[196:199]
    v_mfma_f32_16x16x32_bf16 v[236:239], v[112:115], v[164:167], v[236:239]
    s_waitcnt vmcnt(11) lgkmcnt(0)
    s_barrier
    v_mfma_f32_16x16x32_bf16 v[200:203], v[116:119], v[140:143], v[200:203]
    ds_read_b128 v[148:151], v179 offset:8192
    ds_read_b128 v[152:155], v179 offset:0
    ds_read_b128 v[156:159], v180 offset:8192
    v_mfma_f32_16x16x32_bf16 v[204:207], v[116:119], v[144:147], v[204:207]
    ds_read_b128 v[160:163], v180 offset:0
    ds_read_b64_tr_b16 v[84:85], v168 offset:12288
    ds_read_b64_tr_b16 v[86:87], v168 offset:13056
    v_mfma_f32_16x16x32_bf16 v[208:211], v[120:123], v[140:143], v[208:211]
    ds_read_b64_tr_b16 v[88:89], v171 offset:12288
    ds_read_b64_tr_b16 v[90:91], v171 offset:13056
    ds_read_b64_tr_b16 v[92:93], v169 offset:12288
    v_mfma_f32_16x16x32_bf16 v[212:215], v[120:123], v[144:147], v[212:215]
    ds_read_b64_tr_b16 v[94:95], v169 offset:13056
    ds_read_b64_tr_b16 v[96:97], v172 offset:12288
    ds_read_b64_tr_b16 v[98:99], v172 offset:13056
    v_mfma_f32_16x16x32_bf16 v[216:219], v[124:127], v[140:143], v[216:219]
    ds_read_b64_tr_b16 v[100:101], v170 offset:12288
    ds_read_b64_tr_b16 v[102:103], v170 offset:13056
    ds_read_b64_tr_b16 v[104:105], v173 offset:12288
    v_mfma_f32_16x16x32_bf16 v[220:223], v[124:127], v[144:147], v[220:223]
    ds_read_b64_tr_b16 v[106:107], v173 offset:13056
    s_add_u32 m0, s45, 0
    s_add_u32 s43, s43, 196608
    buffer_load_dwordx4 v174, s[24:27], s43 offen offset:0 lds
    v_mfma_f32_16x16x32_bf16 v[224:227], v[128:131], v[140:143], v[224:227]
    buffer_load_dwordx4 v175, s[24:27], s43 offen offset:1024 lds
    buffer_load_dwordx4 v176, s[24:27], s43 offen offset:2048 lds
    v_mfma_f32_16x16x32_bf16 v[228:231], v[128:131], v[144:147], v[228:231]
    v_mov_b32 v7, s13
    s_lshl_b32 s16, s3, 7
    s_add_u32 s16, s16, 22085632
    s_cmp_eq_u32 s12, 0
    s_cselect_b32 s16, s16, 23068672
    s_mov_b64 exec, 1
    buffer_store_dword v7, v6, s[4:7], s16 offen sc1
    s_mov_b64 exec, -1
    s_add_u32 s16, s3, 3
    s_and_b32 s16, s16, 7
    s_mul_i32 s16, s16, 245760
    s_mov_b64 exec, 0x7fff
    buffer_load_dword v182, v181, s[52:55], s16 offen
    s_mov_b64 exec, -1
    s_waitcnt lgkmcnt(12)
    s_waitcnt lgkmcnt(10)
    v_mfma_f32_16x16x32_bf16 v[184:187], v[84:87], v[148:151], v[184:187]
    ds_read_b64_tr_b16 v[108:109], v168 offset:18432
    ds_read_b64_tr_b16 v[110:111], v168 offset:19200
    v_mfma_f32_16x16x32_bf16 v[188:191], v[84:87], v[152:155], v[188:191]
    s_add_u32 m0, s46, 8192
    s_add_u32 s15, s44, 21632
    ds_read_b64_tr_b16 v[112:113], v171 offset:18432
    v_mfma_f32_16x16x32_bf16 v[232:235], v[84:87], v[164:167], v[232:235]
    ds_read_b64_tr_b16 v[114:115], v171 offset:19200
    s_waitcnt lgkmcnt(12)
    v_mfma_f32_16x16x32_bf16 v[192:195], v[88:91], v[148:151], v[192:195]
    buffer_load_dwordx4 v177, s[20:23], s15 offen offset:0 lds
    v_mfma_f32_16x16x32_bf16 v[196:199], v[88:91], v[152:155], v[196:199]
    ds_read_b64_tr_b16 v[116:117], v169 offset:18432
    v_mfma_f32_16x16x32_bf16 v[236:239], v[88:91], v[164:167], v[236:239]
    ds_read_b64_tr_b16 v[118:119], v169 offset:19200
    s_waitcnt lgkmcnt(12)
    v_mfma_f32_16x16x32_bf16 v[200:203], v[92:95], v[148:151], v[200:203]
    buffer_load_dwordx4 v178, s[20:23], s15 offen offset:1024 lds
    v_mfma_f32_16x16x32_bf16 v[204:207], v[92:95], v[152:155], v[204:207]
    ds_read_b64_tr_b16 v[120:121], v172 offset:18432
    s_waitcnt lgkmcnt(11)
    v_mfma_f32_16x16x32_bf16 v[208:211], v[96:99], v[148:151], v[208:211]
    ds_read_b64_tr_b16 v[122:123], v172 offset:19200
    v_mfma_f32_16x16x32_bf16 v[212:215], v[96:99], v[152:155], v[212:215]
    ds_read_b64_tr_b16 v[124:125], v170 offset:18432
    s_waitcnt lgkmcnt(11)
    v_mfma_f32_16x16x32_bf16 v[216:219], v[100:103], v[148:151], v[216:219]
    ds_read_b64_tr_b16 v[126:127], v170 offset:19200
    v_mfma_f32_16x16x32_bf16 v[220:223], v[100:103], v[152:155], v[220:223]
    ds_read_b64_tr_b16 v[128:129], v173 offset:18432
    s_waitcnt lgkmcnt(11)
    v_mfma_f32_16x16x32_bf16 v[224:227], v[104:107], v[148:151], v[224:227]
    ds_read_b64_tr_b16 v[130:131], v173 offset:19200
    v_mfma_f32_16x16x32_bf16 v[228:231], v[104:107], v[152:155], v[228:231]
    s_add_u32 s16, s3, 4
    s_and_b32 s16, s16, 7
    s_mul_i32 s16, s16, 245760
    s_mov_b64 exec, 0x7fff
    buffer_load_dword v182, v181, s[52:55], s16 offen
    s_mov_b64 exec, -1
    s_waitcnt lgkmcnt(10)
    v_mfma_f32_16x16x32_bf16 v[184:187], v[108:111], v[156:159], v[184:187]
    v_mfma_f32_16x16x32_bf16 v[188:191], v[108:111], v[160:163], v[188:191]
    v_mfma_f32_16x16x32_bf16 v[232:235], v[108:111], v[164:167], v[232:235]
    s_waitcnt lgkmcnt(8)
    v_mfma_f32_16x16x32_bf16 v[192:195], v[112:115], v[156:159], v[192:195]
    v_mfma_f32_16x16x32_bf16 v[196:199], v[112:115], v[160:163], v[196:199]
    v_mfma_f32_16x16x32_bf16 v[236:239], v[112:115], v[164:167], v[236:239]
    s_waitcnt vmcnt(11) lgkmcnt(0)
    s_barrier
    v_mfma_f32_16x16x32_bf16 v[200:203], v[116:119], v[156:159], v[200:203]
    ds_read_b128 v[132:135], v179 offset:2048
    ds_read_b128 v[136:139], v179 offset:4096
    ds_read_b128 v[140:143], v180 offset:2048
    v_mfma_f32_16x16x32_bf16 v[204:207], v[116:119], v[160:163], v[204:207]
    ds_read_b128 v[144:147], v180 offset:4096
    ds_read_b64_tr_b16 v[84:85], v168 offset:24576
    ds_read_b64_tr_b16 v[86:87], v168 offset:25344
    v_mfma_f32_16x16x32_bf16 v[208:211], v[120:123], v[156:159], v[208:211]
    ds_read_b64_tr_b16 v[88:89], v171 offset:24576
    ds_read_b64_tr_b16 v[90:91], v171 offset:25344
    v_mfma_f32_16x16x32_bf16 v[212:215], v[120:123], v[160:163], v[212:215]
    ds_read_b64_tr_b16 v[92:93], v169 offset:24576
    ds_read_b64_tr_b16 v[94:95], v169 offset:25344
    v_mfma_f32_16x16x32_bf16 v[216:219], v[124:127], v[156:159], v[216:219]
    ds_read_b64_tr_b16 v[96:97], v172 offset:24576
    ds_read_b64_tr_b16 v[98:99], v172 offset:25344
    v_mfma_f32_16x16x32_bf16 v[220:223], v[124:127], v[160:163], v[220:223]
    ds_read_b64_tr_b16 v[100:101], v170 offset:24576
    ds_read_b64_tr_b16 v[102:103], v170 offset:25344
    v_mfma_f32_16x16x32_bf16 v[224:227], v[128:131], v[156:159], v[224:227]
    ds_read_b64_tr_b16 v[104:105], v173 offset:24576
    ds_read_b64_tr_b16 v[106:107], v173 offset:25344
    v_mfma_f32_16x16x32_bf16 v[228:231], v[128:131], v[160:163], v[228:231]
    s_lshl_b32 s17, s36, 4
    s_lshl_b32 s16, s12, 2
    s_add_u32 s17, s17, s16
    s_lshl_b32 s17, s17, 7
    s_add_u32 s17, s17, 20971520
    buffer_load_dwordx2 v[240:241], v11, s[4:7], s17 offen offset:0 sc1
    buffer_load_dwordx2 v[242:243], v11, s[4:7], s17 offen offset:256 sc1
    s_add_u32 s16, s3, 5
    s_and_b32 s16, s16, 7
    s_mul_i32 s16, s16, 245760
    s_mov_b64 exec, 0x7fff
    buffer_load_dword v182, v181, s[52:55], s16 offen
    s_mov_b64 exec, -1
    s_waitcnt lgkmcnt(12)
    s_waitcnt lgkmcnt(10)
    v_mfma_f32_16x16x32_bf16 v[184:187], v[84:87], v[132:135], v[184:187]
    ds_read_b64_tr_b16 v[108:109], v168 offset:30720
    v_mfma_f32_16x16x32_bf16 v[188:191], v[84:87], v[136:139], v[188:191]
    ds_read_b64_tr_b16 v[110:111], v168 offset:31488
    v_mfma_f32_16x16x32_bf16 v[232:235], v[84:87], v[164:167], v[232:235]
    ds_read_b64_tr_b16 v[112:113], v171 offset:30720
    s_waitcnt lgkmcnt(11)
    v_mfma_f32_16x16x32_bf16 v[192:195], v[88:91], v[132:135], v[192:195]
    ds_read_b64_tr_b16 v[114:115], v171 offset:31488
    v_mfma_f32_16x16x32_bf16 v[196:199], v[88:91], v[136:139], v[196:199]
    ds_read_b64_tr_b16 v[116:117], v169 offset:30720
    v_mfma_f32_16x16x32_bf16 v[236:239], v[88:91], v[164:167], v[236:239]
    ds_read_b64_tr_b16 v[118:119], v169 offset:31488
    s_waitcnt lgkmcnt(12)
    v_mfma_f32_16x16x32_bf16 v[200:203], v[92:95], v[132:135], v[200:203]
    ds_read_b64_tr_b16 v[120:121], v172 offset:30720
    v_mfma_f32_16x16x32_bf16 v[204:207], v[92:95], v[136:139], v[204:207]
    ds_read_b64_tr_b16 v[122:123], v172 offset:31488
    s_waitcnt lgkmcnt(12)
    v_mfma_f32_16x16x32_bf16 v[208:211], v[96:99], v[132:135], v[208:211]
    ds_read_b64_tr_b16 v[124:125], v170 offset:30720
    v_mfma_f32_16x16x32_bf16 v[212:215], v[96:99], v[136:139], v[212:215]
    ds_read_b64_tr_b16 v[126:127], v170 offset:31488
    s_waitcnt lgkmcnt(12)
    v_mfma_f32_16x16x32_bf16 v[216:219], v[100:103], v[132:135], v[216:219]
    ds_read_b64_tr_b16 v[128:129], v173 offset:30720
    v_mfma_f32_16x16x32_bf16 v[220:223], v[100:103], v[136:139], v[220:223]
    ds_read_b64_tr_b16 v[130:131], v173 offset:31488
    s_waitcnt lgkmcnt(12)
    v_mfma_f32_16x16x32_bf16 v[224:227], v[104:107], v[132:135], v[224:227]
    s_add_u32 s16, s3, 6
    s_and_b32 s16, s16, 7
    s_mul_i32 s16, s16, 245760
    s_mov_b64 exec, 0x7fff
    buffer_load_dword v182, v181, s[52:55], s16 offen
    s_mov_b64 exec, -1
    v_mfma_f32_16x16x32_bf16 v[228:231], v[104:107], v[136:139], v[228:231]
    s_waitcnt lgkmcnt(10)
    v_mfma_f32_16x16x32_bf16 v[184:187], v[108:111], v[140:143], v[184:187]
    v_mfma_f32_16x16x32_bf16 v[188:191], v[108:111], v[144:147], v[188:191]
    v_mfma_f32_16x16x32_bf16 v[232:235], v[108:111], v[164:167], v[232:235]
    s_waitcnt lgkmcnt(8)
    v_mfma_f32_16x16x32_bf16 v[192:195], v[112:115], v[140:143], v[192:195]
    v_mfma_f32_16x16x32_bf16 v[196:199], v[112:115], v[144:147], v[196:199]
    v_mfma_f32_16x16x32_bf16 v[236:239], v[112:115], v[164:167], v[236:239]
    s_waitcnt vmcnt(5) lgkmcnt(0)
    s_barrier
    v_mfma_f32_16x16x32_bf16 v[200:203], v[116:119], v[140:143], v[200:203]
    ds_read_b128 v[148:151], v179 offset:6144
    ds_read_b128 v[152:155], v179 offset:8192
    ds_read_b128 v[156:159], v180 offset:6144
    v_mfma_f32_16x16x32_bf16 v[204:207], v[116:119], v[144:147], v[204:207]
    ds_read_b128 v[160:163], v180 offset:8192
    ds_read_b64_tr_b16 v[84:85], v168 offset:0
    v_mfma_f32_16x16x32_bf16 v[208:211], v[120:123], v[140:143], v[208:211]
    ds_read_b64_tr_b16 v[86:87], v168 offset:768
    ds_read_b64_tr_b16 v[88:89], v171 offset:0
    v_mfma_f32_16x16x32_bf16 v[212:215], v[120:123], v[144:147], v[212:215]
    ds_read_b64_tr_b16 v[90:91], v171 offset:768
    ds_read_b64_tr_b16 v[92:93], v169 offset:0
    v_mfma_f32_16x16x32_bf16 v[216:219], v[124:127], v[140:143], v[216:219]
    ds_read_b64_tr_b16 v[94:95], v169 offset:768
    ds_read_b64_tr_b16 v[96:97], v172 offset:0
    v_mfma_f32_16x16x32_bf16 v[220:223], v[124:127], v[144:147], v[220:223]
    ds_read_b64_tr_b16 v[98:99], v172 offset:768
    ds_read_b64_tr_b16 v[100:101], v170 offset:0
    v_mfma_f32_16x16x32_bf16 v[224:227], v[128:131], v[140:143], v[224:227]
    ds_read_b64_tr_b16 v[102:103], v170 offset:768
    ds_read_b64_tr_b16 v[104:105], v173 offset:0
    v_mfma_f32_16x16x32_bf16 v[228:231], v[128:131], v[144:147], v[228:231]
    ds_read_b64_tr_b16 v[106:107], v173 offset:768
    s_add_u32 s16, s3, 7
    s_and_b32 s16, s16, 7
    s_mul_i32 s16, s16, 245760
    s_mov_b64 exec, 0x7fff
    buffer_load_dword v182, v181, s[52:55], s16 offen
    s_mov_b64 exec, -1
    s_waitcnt lgkmcnt(12)
    s_waitcnt lgkmcnt(10)
    v_mfma_f32_16x16x32_bf16 v[184:187], v[84:87], v[148:151], v[184:187]
    ds_read_b64_tr_b16 v[108:109], v168 offset:6144
    v_mfma_f32_16x16x32_bf16 v[188:191], v[84:87], v[152:155], v[188:191]
    ds_read_b64_tr_b16 v[110:111], v168 offset:6912
    v_mfma_f32_16x16x32_bf16 v[232:235], v[84:87], v[164:167], v[232:235]
    ds_read_b64_tr_b16 v[112:113], v171 offset:6144
    s_waitcnt lgkmcnt(11)
    v_mfma_f32_16x16x32_bf16 v[192:195], v[88:91], v[148:151], v[192:195]
    ds_read_b64_tr_b16 v[114:115], v171 offset:6912
    v_mfma_f32_16x16x32_bf16 v[196:199], v[88:91], v[152:155], v[196:199]
    ds_read_b64_tr_b16 v[116:117], v169 offset:6144
    v_mfma_f32_16x16x32_bf16 v[236:239], v[88:91], v[164:167], v[236:239]
    ds_read_b64_tr_b16 v[118:119], v169 offset:6912
    s_waitcnt lgkmcnt(12)
    v_mfma_f32_16x16x32_bf16 v[200:203], v[92:95], v[148:151], v[200:203]
    ds_read_b64_tr_b16 v[120:121], v172 offset:6144
    v_mfma_f32_16x16x32_bf16 v[204:207], v[92:95], v[152:155], v[204:207]
    ds_read_b64_tr_b16 v[122:123], v172 offset:6912
    s_waitcnt lgkmcnt(12)
    v_mfma_f32_16x16x32_bf16 v[208:211], v[96:99], v[148:151], v[208:211]
    ds_read_b64_tr_b16 v[124:125], v170 offset:6144
    v_mfma_f32_16x16x32_bf16 v[212:215], v[96:99], v[152:155], v[212:215]
    ds_read_b64_tr_b16 v[126:127], v170 offset:6912
    s_waitcnt lgkmcnt(12)
    v_mfma_f32_16x16x32_bf16 v[216:219], v[100:103], v[148:151], v[216:219]
    ds_read_b64_tr_b16 v[128:129], v173 offset:6144
    v_mfma_f32_16x16x32_bf16 v[220:223], v[100:103], v[152:155], v[220:223]
    ds_read_b64_tr_b16 v[130:131], v173 offset:6912
    s_waitcnt lgkmcnt(12)
    v_mfma_f32_16x16x32_bf16 v[224:227], v[104:107], v[148:151], v[224:227]
    v_mfma_f32_16x16x32_bf16 v[228:231], v[104:107], v[152:155], v[228:231]
    s_waitcnt lgkmcnt(10)
    v_mfma_f32_16x16x32_bf16 v[184:187], v[108:111], v[156:159], v[184:187]
    v_mfma_f32_16x16x32_bf16 v[188:191], v[108:111], v[160:163], v[188:191]
    v_mfma_f32_16x16x32_bf16 v[232:235], v[108:111], v[164:167], v[232:235]
    s_waitcnt lgkmcnt(8)
    v_mfma_f32_16x16x32_bf16 v[192:195], v[112:115], v[156:159], v[192:195]
    v_mfma_f32_16x16x32_bf16 v[196:199], v[112:115], v[160:163], v[196:199]
    v_mfma_f32_16x16x32_bf16 v[236:239], v[112:115], v[164:167], v[236:239]
    s_waitcnt lgkmcnt(6)
    v_mfma_f32_16x16x32_bf16 v[200:203], v[116:119], v[156:159], v[200:203]
    v_mfma_f32_16x16x32_bf16 v[204:207], v[116:119], v[160:163], v[204:207]
    s_waitcnt lgkmcnt(4)
    v_mfma_f32_16x16x32_bf16 v[208:211], v[120:123], v[156:159], v[208:211]
    v_mfma_f32_16x16x32_bf16 v[212:215], v[120:123], v[160:163], v[212:215]
    s_waitcnt lgkmcnt(2)
    v_mfma_f32_16x16x32_bf16 v[216:219], v[124:127], v[156:159], v[216:219]
    v_mfma_f32_16x16x32_bf16 v[220:223], v[124:127], v[160:163], v[220:223]
    s_waitcnt lgkmcnt(0)
    v_mfma_f32_16x16x32_bf16 v[224:227], v[128:131], v[156:159], v[224:227]
    v_mfma_f32_16x16x32_bf16 v[228:231], v[128:131], v[160:163], v[228:231]
    v_lshrrev_b32 v2, 4, v1
    v_lshlrev_b32 v180, 4, v2
    s_lshl_b32 s15, s40, 7
    v_add_u32 v3, s15, v180
    ds_write_b128 v3, v[232:235] offset:24576
    ds_write_b128 v3, v[236:239] offset:24640
    s_waitcnt vmcnt(3)
    v_cmp_ne_u32 vcc, s13, v241
    v_cmp_ne_u32 s[18:19], s13, v243
    s_nop 0
    s_or_b64 vcc, vcc, s[18:19]
    s_cmp_eq_u64 vcc, 0
    s_cbranch_scc1 FD_3
    s_mov_b32 s14, 0
FL_4:
    s_sleep 2
    s_mov_b64 exec, vcc
    buffer_load_dwordx2 v[240:241], v11, s[4:7], s17 offen offset:0 sc1
    buffer_load_dwordx2 v[242:243], v11, s[4:7], s17 offen offset:256 sc1
    s_mov_b64 exec, -1
    s_waitcnt vmcnt(0)
    v_cmp_ne_u32 vcc, s13, v241
    v_cmp_ne_u32 s[18:19], s13, v243
    s_nop 0
    s_or_b64 vcc, vcc, s[18:19]
    s_cmp_eq_u64 vcc, 0
    s_cbranch_scc1 FD_3
    s_add_u32 s14, s14, 1
    s_cmp_lt_u32 s14, 16384
    s_cbranch_scc1 FL_4
FD_3:
    s_waitcnt lgkmcnt(0)
    s_barrier
    s_lshl_b32 s15, s40, 7
    v_add_u32 v3, s15, v180
    ds_read_b128 v[112:115], v3 offset:24576
    ds_read_b128 v[116:119], v3 offset:24640
    s_lshl_b32 s15, s41, 7
    v_add_u32 v3, s15, v180
    ds_read_b128 v[120:123], v3 offset:24576
    ds_read_b128 v[124:127], v3 offset:24640
    s_lshl_b32 s15, s42, 7
    v_add_u32 v3, s15, v180
    ds_read_b128 v[128:131], v3 offset:24576
    ds_read_b128 v[132:135], v3 offset:24640
    v_and_b32 v3, 0xffff0000, v240
    v_rcp_f32 v160, v3
    v_lshlrev_b32 v4, 16, v240
    v_mul_f32 v161, v4, v160
    v_sub_f32 v240, 0, v161
    v_and_b32 v3, 0xffff0000, v242
    v_rcp_f32 v162, v3
    v_lshlrev_b32 v4, 16, v242
    v_mul_f32 v163, v4, v162
    v_sub_f32 v242, 0, v163
    v_lshlrev_b32 v136, 16, v244
    v_and_b32 v137, 0xffff0000, v244
    v_lshlrev_b32 v138, 16, v245
    v_and_b32 v139, 0xffff0000, v245
    v_lshlrev_b32 v140, 16, v246
    v_and_b32 v141, 0xffff0000, v246
    v_lshlrev_b32 v142, 16, v247
    v_and_b32 v143, 0xffff0000, v247
    v_lshlrev_b32 v144, 16, v248
    v_and_b32 v145, 0xffff0000, v248
    v_lshlrev_b32 v146, 16, v249
    v_and_b32 v147, 0xffff0000, v249
    v_lshlrev_b32 v148, 16, v250
    v_and_b32 v149, 0xffff0000, v250
    v_lshlrev_b32 v150, 16, v251
    v_and_b32 v151, 0xffff0000, v251
    v_lshlrev_b32 v152, 16, v252
    v_and_b32 v153, 0xffff0000, v252
    v_lshlrev_b32 v154, 16, v253
    v_and_b32 v155, 0xffff0000, v253
    v_lshlrev_b32 v156, 16, v254
    v_and_b32 v157, 0xffff0000, v254
    v_lshlrev_b32 v158, 16, v255
    v_and_b32 v159, 0xffff0000, v255
    s_lshl_b32 s15, s36, 3
    s_lshl_b32 s16, s12, 1
    s_add_u32 s15, s15, s16
    s_mul_i32 s15, s15, 48
    s_mul_i32 s16, s37, 3
    s_add_u32 s15, s15, s16
    s_add_u32 s40, s40, s15
    s_lshl_b32 s40, s40, 10
    s_add_u32 s40, s40, 12582912
    s_add_u32 s41, s41, s15
    s_lshl_b32 s41, s41, 10
    s_add_u32 s41, s41, 12582912
    s_add_u32 s42, s42, s15
    s_lshl_b32 s42, s42, 10
    s_add_u32 s42, s42, 12582912
    s_mov_b32 s50, 0x3fb8aa3b
    s_mov_b32 s51, 0x3fb8aa3b
    s_mul_i32 s45, s12, 20480
    s_waitcnt lgkmcnt(0)
    v_pk_fma_f32 v[164:165], v[112:113], v[240:241], v[136:137] op_sel_hi:[1,0,1]
    v_pk_fma_f32 v[184:185], v[184:185], v[160:161], v[164:165] op_sel_hi:[1,0,1]
    v_pk_fma_f32 v[166:167], v[114:115], v[240:241], v[138:139] op_sel_hi:[1,0,1]
    v_pk_fma_f32 v[186:187], v[186:187], v[160:161], v[166:167] op_sel_hi:[1,0,1]
    v_pk_fma_f32 v[168:169], v[116:117], v[240:241], v[140:141] op_sel_hi:[1,0,1]
    v_pk_fma_f32 v[192:193], v[192:193], v[160:161], v[168:169] op_sel_hi:[1,0,1]
    v_pk_fma_f32 v[170:171], v[118:119], v[240:241], v[142:143] op_sel_hi:[1,0,1]
    v_pk_fma_f32 v[194:195], v[194:195], v[160:161], v[170:171] op_sel_hi:[1,0,1]
    v_pk_mul_f32 v[164:165], v[184:185], s[50:51]
    v_pk_mul_f32 v[166:167], v[186:187], s[50:51]
    v_pk_mul_f32 v[168:169], v[192:193], s[50:51]
    v_pk_mul_f32 v[170:171], v[194:195], s[50:51]
    v_min_f32 v164, 0x41f00000, v164
    v_min_f32 v165, 0x41f00000, v165
    v_min_f32 v166, 0x41f00000, v166
    v_min_f32 v167, 0x41f00000, v167
    v_min_f32 v168, 0x41f00000, v168
    v_min_f32 v169, 0x41f00000, v169
    v_min_f32 v170, 0x41f00000, v170
    v_min_f32 v171, 0x41f00000, v171
    v_exp_f32 v164, v164
    v_exp_f32 v165, v165
    v_exp_f32 v166, v166
    v_exp_f32 v167, v167
    v_exp_f32 v168, v168
    v_exp_f32 v169, v169
    v_exp_f32 v170, v170
    v_exp_f32 v171, v171
    v_pk_add_f32 v[172:173], v[164:165], 2.0 op_sel_hi:[1,0]
    v_pk_add_f32 v[174:175], v[166:167], 2.0 op_sel_hi:[1,0]
    v_pk_add_f32 v[176:177], v[168:169], 2.0 op_sel_hi:[1,0]
    v_pk_add_f32 v[178:179], v[170:171], 2.0 op_sel_hi:[1,0]
    v_pk_mul_f32 v[164:165], v[164:165], v[172:173]
    v_pk_mul_f32 v[166:167], v[166:167], v[174:175]
    v_pk_mul_f32 v[168:169], v[168:169], v[176:177]
    v_pk_mul_f32 v[170:171], v[170:171], v[178:179]
    v_pk_add_f32 v[172:173], v[164:165], 2.0 op_sel_hi:[1,0]
    v_pk_add_f32 v[174:175], v[166:167], 2.0 op_sel_hi:[1,0]
    v_pk_add_f32 v[176:177], v[168:169], 2.0 op_sel_hi:[1,0]
    v_pk_add_f32 v[178:179], v[170:171], 2.0 op_sel_hi:[1,0]
    v_rcp_f32 v172, v172
    v_rcp_f32 v173, v173
    v_rcp_f32 v174, v174
    v_rcp_f32 v175, v175
    v_rcp_f32 v176, v176
    v_rcp_f32 v177, v177
    v_rcp_f32 v178, v178
    v_rcp_f32 v179, v179
    v_pk_mul_f32 v[184:185], v[184:185], v[164:165]
    v_pk_mul_f32 v[186:187], v[186:187], v[166:167]
    v_pk_mul_f32 v[192:193], v[192:193], v[168:169]
    v_pk_mul_f32 v[194:195], v[194:195], v[170:171]
    v_pk_mul_f32 v[184:185], v[184:185], v[172:173]
    v_pk_mul_f32 v[186:187], v[186:187], v[174:175]
    v_pk_mul_f32 v[192:193], v[192:193], v[176:177]
    v_pk_mul_f32 v[194:195], v[194:195], v[178:179]
    v_cvt_pk_bf16_f32 v232, v184, v185
    v_cvt_pk_bf16_f32 v233, v186, v187
    v_cvt_pk_bf16_f32 v234, v192, v193
    v_cvt_pk_bf16_f32 v235, v194, v195
    buffer_store_dwordx4 v[232:235], v8, s[4:7], s40 offen sc1
    v_pk_fma_f32 v[164:165], v[112:113], v[242:243], v[136:137] op_sel_hi:[1,0,1]
    v_pk_fma_f32 v[188:189], v[188:189], v[162:163], v[164:165] op_sel_hi:[1,0,1]
    v_pk_fma_f32 v[166:167], v[114:115], v[242:243], v[138:139] op_sel_hi:[1,0,1]
    v_pk_fma_f32 v[190:191], v[190:191], v[162:163], v[166:167] op_sel_hi:[1,0,1]
    v_pk_fma_f32 v[168:169], v[116:117], v[242:243], v[140:141] op_sel_hi:[1,0,1]
    v_pk_fma_f32 v[196:197], v[196:197], v[162:163], v[168:169] op_sel_hi:[1,0,1]
    v_pk_fma_f32 v[170:171], v[118:119], v[242:243], v[142:143] op_sel_hi:[1,0,1]
    v_pk_fma_f32 v[198:199], v[198:199], v[162:163], v[170:171] op_sel_hi:[1,0,1]
    v_pk_mul_f32 v[164:165], v[188:189], s[50:51]
    v_pk_mul_f32 v[166:167], v[190:191], s[50:51]
    v_pk_mul_f32 v[168:169], v[196:197], s[50:51]
    v_pk_mul_f32 v[170:171], v[198:199], s[50:51]
    v_min_f32 v164, 0x41f00000, v164
    v_min_f32 v165, 0x41f00000, v165
    v_min_f32 v166, 0x41f00000, v166
    v_min_f32 v167, 0x41f00000, v167
    v_min_f32 v168, 0x41f00000, v168
    v_min_f32 v169, 0x41f00000, v169
    v_min_f32 v170, 0x41f00000, v170
    v_min_f32 v171, 0x41f00000, v171
    v_exp_f32 v164, v164
    v_exp_f32 v165, v165
    v_exp_f32 v166, v166
    v_exp_f32 v167, v167
    v_exp_f32 v168, v168
    v_exp_f32 v169, v169
    v_exp_f32 v170, v170
    v_exp_f32 v171, v171
    v_pk_add_f32 v[172:173], v[164:165], 2.0 op_sel_hi:[1,0]
    v_pk_add_f32 v[174:175], v[166:167], 2.0 op_sel_hi:[1,0]
    v_pk_add_f32 v[176:177], v[168:169], 2.0 op_sel_hi:[1,0]
    v_pk_add_f32 v[178:179], v[170:171], 2.0 op_sel_hi:[1,0]
    v_pk_mul_f32 v[164:165], v[164:165], v[172:173]
    v_pk_mul_f32 v[166:167], v[166:167], v[174:175]
    v_pk_mul_f32 v[168:169], v[168:169], v[176:177]
    v_pk_mul_f32 v[170:171], v[170:171], v[178:179]
    v_pk_add_f32 v[172:173], v[164:165], 2.0 op_sel_hi:[1,0]
    v_pk_add_f32 v[174:175], v[166:167], 2.0 op_sel_hi:[1,0]
    v_pk_add_f32 v[176:177], v[168:169], 2.0 op_sel_hi:[1,0]
    v_pk_add_f32 v[178:179], v[170:171], 2.0 op_sel_hi:[1,0]
    v_rcp_f32 v172, v172
    v_rcp_f32 v173, v173
    v_rcp_f32 v174, v174
    v_rcp_f32 v175, v175
    v_rcp_f32 v176, v176
    v_rcp_f32 v177, v177
    v_rcp_f32 v178, v178
    v_rcp_f32 v179, v179
    v_pk_mul_f32 v[188:189], v[188:189], v[164:165]
    v_pk_mul_f32 v[190:191], v[190:191], v[166:167]
    v_pk_mul_f32 v[196:197], v[196:197], v[168:169]
    v_pk_mul_f32 v[198:199], v[198:199], v[170:171]
    v_pk_mul_f32 v[188:189], v[188:189], v[172:173]
    v_pk_mul_f32 v[190:191], v[190:191], v[174:175]
    v_pk_mul_f32 v[196:197], v[196:197], v[176:177]
    v_pk_mul_f32 v[198:199], v[198:199], v[178:179]
    v_cvt_pk_bf16_f32 v236, v188, v189
    v_cvt_pk_bf16_f32 v237, v190, v191
    v_cvt_pk_bf16_f32 v238, v196, v197
    v_cvt_pk_bf16_f32 v239, v198, v199
    s_add_u32 s15, s40, 49152
    buffer_store_dwordx4 v[236:239], v8, s[4:7], s15 offen sc1
    v_pk_fma_f32 v[164:165], v[120:121], v[240:241], v[144:145] op_sel_hi:[1,0,1]
    v_pk_fma_f32 v[200:201], v[200:201], v[160:161], v[164:165] op_sel_hi:[1,0,1]
    v_pk_fma_f32 v[166:167], v[122:123], v[240:241], v[146:147] op_sel_hi:[1,0,1]
    v_pk_fma_f32 v[202:203], v[202:203], v[160:161], v[166:167] op_sel_hi:[1,0,1]
    v_pk_fma_f32 v[168:169], v[124:125], v[240:241], v[148:149] op_sel_hi:[1,0,1]
    v_pk_fma_f32 v[208:209], v[208:209], v[160:161], v[168:169] op_sel_hi:[1,0,1]
    v_pk_fma_f32 v[170:171], v[126:127], v[240:241], v[150:151] op_sel_hi:[1,0,1]
    v_pk_fma_f32 v[210:211], v[210:211], v[160:161], v[170:171] op_sel_hi:[1,0,1]
    v_pk_mul_f32 v[164:165], v[200:201], s[50:51]
    v_pk_mul_f32 v[166:167], v[202:203], s[50:51]
    v_pk_mul_f32 v[168:169], v[208:209], s[50:51]
    v_pk_mul_f32 v[170:171], v[210:211], s[50:51]
    v_min_f32 v164, 0x41f00000, v164
    v_min_f32 v165, 0x41f00000, v165
    v_min_f32 v166, 0x41f00000, v166
    v_min_f32 v167, 0x41f00000, v167
    v_min_f32 v168, 0x41f00000, v168
    v_min_f32 v169, 0x41f00000, v169
    v_min_f32 v170, 0x41f00000, v170
    v_min_f32 v171, 0x41f00000, v171
    v_exp_f32 v164, v164
    v_exp_f32 v165, v165
    v_exp_f32 v166, v166
    v_exp_f32 v167, v167
    v_exp_f32 v168, v168
    v_exp_f32 v169, v169
    v_exp_f32 v170, v170
    v_exp_f32 v171, v171
    v_pk_add_f32 v[172:173], v[164:165], 2.0 op_sel_hi:[1,0]
    v_pk_add_f32 v[174:175], v[166:167], 2.0 op_sel_hi:[1,0]
    v_pk_add_f32 v[176:177], v[168:169], 2.0 op_sel_hi:[1,0]
    v_pk_add_f32 v[178:179], v[170:171], 2.0 op_sel_hi:[1,0]
    v_pk_mul_f32 v[164:165], v[164:165], v[172:173]
    v_pk_mul_f32 v[166:167], v[166:167], v[174:175]
    v_pk_mul_f32 v[168:169], v[168:169], v[176:177]
    v_pk_mul_f32 v[170:171], v[170:171], v[178:179]
    v_pk_add_f32 v[172:173], v[164:165], 2.0 op_sel_hi:[1,0]
    v_pk_add_f32 v[174:175], v[166:167], 2.0 op_sel_hi:[1,0]
    v_pk_add_f32 v[176:177], v[168:169], 2.0 op_sel_hi:[1,0]
    v_pk_add_f32 v[178:179], v[170:171], 2.0 op_sel_hi:[1,0]
    v_rcp_f32 v172, v172
    v_rcp_f32 v173, v173
    v_rcp_f32 v174, v174
    v_rcp_f32 v175, v175
    v_rcp_f32 v176, v176
    v_rcp_f32 v177, v177
    v_rcp_f32 v178, v178
    v_rcp_f32 v179, v179
    v_pk_mul_f32 v[200:201], v[200:201], v[164:165]
    v_pk_mul_f32 v[202:203], v[202:203], v[166:167]
    v_pk_mul_f32 v[208:209], v[208:209], v[168:169]
    v_pk_mul_f32 v[210:211], v[210:211], v[170:171]
    v_pk_mul_f32 v[200:201], v[200:201], v[172:173]
    v_pk_mul_f32 v[202:203], v[202:203], v[174:175]
    v_pk_mul_f32 v[208:209], v[208:209], v[176:177]
    v_pk_mul_f32 v[210:211], v[210:211], v[178:179]
    v_cvt_pk_bf16_f32 v232, v200, v201
    v_cvt_pk_bf16_f32 v233, v202, v203
    v_cvt_pk_bf16_f32 v234, v208, v209
    v_cvt_pk_bf16_f32 v235, v210, v211
    buffer_store_dwordx4 v[232:235], v8, s[4:7], s41 offen sc1
    v_pk_fma_f32 v[164:165], v[120:121], v[242:243], v[144:145] op_sel_hi:[1,0,1]
    v_pk_fma_f32 v[204:205], v[204:205], v[162:163], v[164:165] op_sel_hi:[1,0,1]
    v_pk_fma_f32 v[166:167], v[122:123], v[242:243], v[146:147] op_sel_hi:[1,0,1]
    v_pk_fma_f32 v[206:207], v[206:207], v[162:163], v[166:167] op_sel_hi:[1,0,1]
    v_pk_fma_f32 v[168:169], v[124:125], v[242:243], v[148:149] op_sel_hi:[1,0,1]
    v_pk_fma_f32 v[212:213], v[212:213], v[162:163], v[168:169] op_sel_hi:[1,0,1]
    v_pk_fma_f32 v[170:171], v[126:127], v[242:243], v[150:151] op_sel_hi:[1,0,1]
    v_pk_fma_f32 v[214:215], v[214:215], v[162:163], v[170:171] op_sel_hi:[1,0,1]
    v_pk_mul_f32 v[164:165], v[204:205], s[50:51]
    v_pk_mul_f32 v[166:167], v[206:207], s[50:51]
    v_pk_mul_f32 v[168:169], v[212:213], s[50:51]
    v_pk_mul_f32 v[170:171], v[214:215], s[50:51]
    v_min_f32 v164, 0x41f00000, v164
    v_min_f32 v165, 0x41f00000, v165
    v_min_f32 v166, 0x41f00000, v166
    v_min_f32 v167, 0x41f00000, v167
    v_min_f32 v168, 0x41f00000, v168
    v_min_f32 v169, 0x41f00000, v169
    v_min_f32 v170, 0x41f00000, v170
    v_min_f32 v171, 0x41f00000, v171
    v_exp_f32 v164, v164
    v_exp_f32 v165, v165
    v_exp_f32 v166, v166
    v_exp_f32 v167, v167
    v_exp_f32 v168, v168
    v_exp_f32 v169, v169
    v_exp_f32 v170, v170
    v_exp_f32 v171, v171
    v_pk_add_f32 v[172:173], v[164:165], 2.0 op_sel_hi:[1,0]
    v_pk_add_f32 v[174:175], v[166:167], 2.0 op_sel_hi:[1,0]
    v_pk_add_f32 v[176:177], v[168:169], 2.0 op_sel_hi:[1,0]
    v_pk_add_f32 v[178:179], v[170:171], 2.0 op_sel_hi:[1,0]
    v_pk_mul_f32 v[164:165], v[164:165], v[172:173]
    v_pk_mul_f32 v[166:167], v[166:167], v[174:175]
    v_pk_mul_f32 v[168:169], v[168:169], v[176:177]
    v_pk_mul_f32 v[170:171], v[170:171], v[178:179]
    v_pk_add_f32 v[172:173], v[164:165], 2.0 op_sel_hi:[1,0]
    v_pk_add_f32 v[174:175], v[166:167], 2.0 op_sel_hi:[1,0]
    v_pk_add_f32 v[176:177], v[168:169], 2.0 op_sel_hi:[1,0]
    v_pk_add_f32 v[178:179], v[170:171], 2.0 op_sel_hi:[1,0]
    v_rcp_f32 v172, v172
    v_rcp_f32 v173, v173
    v_rcp_f32 v174, v174
    v_rcp_f32 v175, v175
    v_rcp_f32 v176, v176
    v_rcp_f32 v177, v177
    v_rcp_f32 v178, v178
    v_rcp_f32 v179, v179
    v_pk_mul_f32 v[204:205], v[204:205], v[164:165]
    v_pk_mul_f32 v[206:207], v[206:207], v[166:167]
    v_pk_mul_f32 v[212:213], v[212:213], v[168:169]
    v_pk_mul_f32 v[214:215], v[214:215], v[170:171]
    v_pk_mul_f32 v[204:205], v[204:205], v[172:173]
    v_pk_mul_f32 v[206:207], v[206:207], v[174:175]
    v_pk_mul_f32 v[212:213], v[212:213], v[176:177]
    v_pk_mul_f32 v[214:215], v[214:215], v[178:179]
    v_cvt_pk_bf16_f32 v236, v204, v205
    v_cvt_pk_bf16_f32 v237, v206, v207
    v_cvt_pk_bf16_f32 v238, v212, v213
    v_cvt_pk_bf16_f32 v239, v214, v215
    s_add_u32 s15, s41, 49152
    buffer_store_dwordx4 v[236:239], v8, s[4:7], s15 offen sc1
    v_pk_fma_f32 v[164:165], v[128:129], v[240:241], v[152:153] op_sel_hi:[1,0,1]
    v_pk_fma_f32 v[216:217], v[216:217], v[160:161], v[164:165] op_sel_hi:[1,0,1]
    v_pk_fma_f32 v[166:167], v[130:131], v[240:241], v[154:155] op_sel_hi:[1,0,1]
    v_pk_fma_f32 v[218:219], v[218:219], v[160:161], v[166:167] op_sel_hi:[1,0,1]
    v_pk_fma_f32 v[168:169], v[132:133], v[240:241], v[156:157] op_sel_hi:[1,0,1]
    v_pk_fma_f32 v[224:225], v[224:225], v[160:161], v[168:169] op_sel_hi:[1,0,1]
    v_pk_fma_f32 v[170:171], v[134:135], v[240:241], v[158:159] op_sel_hi:[1,0,1]
    v_pk_fma_f32 v[226:227], v[226:227], v[160:161], v[170:171] op_sel_hi:[1,0,1]
    v_pk_mul_f32 v[164:165], v[216:217], s[50:51]
    v_pk_mul_f32 v[166:167], v[218:219], s[50:51]
    v_pk_mul_f32 v[168:169], v[224:225], s[50:51]
    v_pk_mul_f32 v[170:171], v[226:227], s[50:51]
    v_min_f32 v164, 0x41f00000, v164
    v_min_f32 v165, 0x41f00000, v165
    v_min_f32 v166, 0x41f00000, v166
    v_min_f32 v167, 0x41f00000, v167
    v_min_f32 v168, 0x41f00000, v168
    v_min_f32 v169, 0x41f00000, v169
    v_min_f32 v170, 0x41f00000, v170
    v_min_f32 v171, 0x41f00000, v171
    v_exp_f32 v164, v164
    v_exp_f32 v165, v165
    v_exp_f32 v166, v166
    v_exp_f32 v167, v167
    v_exp_f32 v168, v168
    v_exp_f32 v169, v169
    v_exp_f32 v170, v170
    v_exp_f32 v171, v171
    v_pk_add_f32 v[172:173], v[164:165], 2.0 op_sel_hi:[1,0]
    v_pk_add_f32 v[174:175], v[166:167], 2.0 op_sel_hi:[1,0]
    v_pk_add_f32 v[176:177], v[168:169], 2.0 op_sel_hi:[1,0]
    v_pk_add_f32 v[178:179], v[170:171], 2.0 op_sel_hi:[1,0]
    v_pk_mul_f32 v[164:165], v[164:165], v[172:173]
    v_pk_mul_f32 v[166:167], v[166:167], v[174:175]
    v_pk_mul_f32 v[168:169], v[168:169], v[176:177]
    v_pk_mul_f32 v[170:171], v[170:171], v[178:179]
    v_pk_add_f32 v[172:173], v[164:165], 2.0 op_sel_hi:[1,0]
    v_pk_add_f32 v[174:175], v[166:167], 2.0 op_sel_hi:[1,0]
    v_pk_add_f32 v[176:177], v[168:169], 2.0 op_sel_hi:[1,0]
    v_pk_add_f32 v[178:179], v[170:171], 2.0 op_sel_hi:[1,0]
    v_rcp_f32 v172, v172
    v_rcp_f32 v173, v173
    v_rcp_f32 v174, v174
    v_rcp_f32 v175, v175
    v_rcp_f32 v176, v176
    v_rcp_f32 v177, v177
    v_rcp_f32 v178, v178
    v_rcp_f32 v179, v179
    v_pk_mul_f32 v[216:217], v[216:217], v[164:165]
    v_pk_mul_f32 v[218:219], v[218:219], v[166:167]
    v_pk_mul_f32 v[224:225], v[224:225], v[168:169]
    v_pk_mul_f32 v[226:227], v[226:227], v[170:171]
    v_pk_mul_f32 v[216:217], v[216:217], v[172:173]
    v_pk_mul_f32 v[218:219], v[218:219], v[174:175]
    v_pk_mul_f32 v[224:225], v[224:225], v[176:177]
    v_pk_mul_f32 v[226:227], v[226:227], v[178:179]
    v_cvt_pk_bf16_f32 v232, v216, v217
    v_cvt_pk_bf16_f32 v233, v218, v219
    v_cvt_pk_bf16_f32 v234, v224, v225
    v_cvt_pk_bf16_f32 v235, v226, v227
    buffer_store_dwordx4 v[232:235], v8, s[4:7], s42 offen sc1
    v_pk_fma_f32 v[164:165], v[128:129], v[242:243], v[152:153] op_sel_hi:[1,0,1]
    v_pk_fma_f32 v[220:221], v[220:221], v[162:163], v[164:165] op_sel_hi:[1,0,1]
    v_pk_fma_f32 v[166:167], v[130:131], v[242:243], v[154:155] op_sel_hi:[1,0,1]
    v_pk_fma_f32 v[222:223], v[222:223], v[162:163], v[166:167] op_sel_hi:[1,0,1]
    v_pk_fma_f32 v[168:169], v[132:133], v[242:243], v[156:157] op_sel_hi:[1,0,1]
    v_pk_fma_f32 v[228:229], v[228:229], v[162:163], v[168:169] op_sel_hi:[1,0,1]
    v_pk_fma_f32 v[170:171], v[134:135], v[242:243], v[158:159] op_sel_hi:[1,0,1]
    v_pk_fma_f32 v[230:231], v[230:231], v[162:163], v[170:171] op_sel_hi:[1,0,1]
    v_pk_mul_f32 v[164:165], v[220:221], s[50:51]
    v_pk_mul_f32 v[166:167], v[222:223], s[50:51]
    v_pk_mul_f32 v[168:169], v[228:229], s[50:51]
    v_pk_mul_f32 v[170:171], v[230:231], s[50:51]
    v_min_f32 v164, 0x41f00000, v164
    v_min_f32 v165, 0x41f00000, v165
    v_min_f32 v166, 0x41f00000, v166
    v_min_f32 v167, 0x41f00000, v167
    v_min_f32 v168, 0x41f00000, v168
    v_min_f32 v169, 0x41f00000, v169
    v_min_f32 v170, 0x41f00000, v170
    v_min_f32 v171, 0x41f00000, v171
    v_exp_f32 v164, v164
    v_exp_f32 v165, v165
    v_exp_f32 v166, v166
    v_exp_f32 v167, v167
    v_exp_f32 v168, v168
    v_exp_f32 v169, v169
    v_exp_f32 v170, v170
    v_exp_f32 v171, v171
    v_pk_add_f32 v[172:173], v[164:165], 2.0 op_sel_hi:[1,0]
    v_pk_add_f32 v[174:175], v[166:167], 2.0 op_sel_hi:[1,0]
    v_pk_add_f32 v[176:177], v[168:169], 2.0 op_sel_hi:[1,0]
    v_pk_add_f32 v[178:179], v[170:171], 2.0 op_sel_hi:[1,0]
    v_pk_mul_f32 v[164:165], v[164:165], v[172:173]
    v_pk_mul_f32 v[166:167], v[166:167], v[174:175]
    v_pk_mul_f32 v[168:169], v[168:169], v[176:177]
    v_pk_mul_f32 v[170:171], v[170:171], v[178:179]
    v_pk_add_f32 v[172:173], v[164:165], 2.0 op_sel_hi:[1,0]
    v_pk_add_f32 v[174:175], v[166:167], 2.0 op_sel_hi:[1,0]
    v_pk_add_f32 v[176:177], v[168:169], 2.0 op_sel_hi:[1,0]
    v_pk_add_f32 v[178:179], v[170:171], 2.0 op_sel_hi:[1,0]
    v_rcp_f32 v172, v172
    v_rcp_f32 v173, v173
    v_rcp_f32 v174, v174
    v_rcp_f32 v175, v175
    v_rcp_f32 v176, v176
    v_rcp_f32 v177, v177
    v_rcp_f32 v178, v178
    v_rcp_f32 v179, v179
    v_pk_mul_f32 v[220:221], v[220:221], v[164:165]
    v_pk_mul_f32 v[222:223], v[222:223], v[166:167]
    v_pk_mul_f32 v[228:229], v[228:229], v[168:169]
    v_pk_mul_f32 v[230:231], v[230:231], v[170:171]
    v_pk_mul_f32 v[220:221], v[220:221], v[172:173]
    v_pk_mul_f32 v[222:223], v[222:223], v[174:175]
    v_pk_mul_f32 v[228:229], v[228:229], v[176:177]
    v_pk_mul_f32 v[230:231], v[230:231], v[178:179]
    v_cvt_pk_bf16_f32 v236, v220, v221
    v_cvt_pk_bf16_f32 v237, v222, v223
    v_cvt_pk_bf16_f32 v238, v228, v229
    v_cvt_pk_bf16_f32 v239, v230, v231
    s_add_u32 s15, s42, 49152
    buffer_store_dwordx4 v[236:239], v8, s[4:7], s15 offen sc1
    v_add_u32 v2, 0, v1
    v_mul_u32_u24 v3, 0xcccd, v2
    v_lshrrev_b32 v3, 19, v3
    v_mul_u32_u24 v4, 10, v3
    v_sub_u32 v4, v2, v4
    v_mul_u32_u24 v3, 1280, v3
    v_lshl_add_u32 v246, v4, 4, v3
    v_add_u32 v2, 64, v1
    v_mul_u32_u24 v3, 0xcccd, v2
    v_lshrrev_b32 v3, 19, v3
    v_mul_u32_u24 v4, 10, v3
    v_sub_u32 v4, v2, v4
    v_mul_u32_u24 v3, 1280, v3
    v_lshl_add_u32 v247, v4, 4, v3
    v_subrev_u32 v247, 1024, v247
    v_add_u32 v2, 128, v1
    v_mul_u32_u24 v3, 0xcccd, v2
    v_lshrrev_b32 v3, 19, v3
    v_mul_u32_u24 v4, 10, v3
    v_sub_u32 v4, v2, v4
    v_mul_u32_u24 v3, 1280, v3
    v_lshl_add_u32 v248, v4, 4, v3
    v_subrev_u32 v248, 2048, v248
    v_add_u32 v2, 192, v1
    v_mul_u32_u24 v3, 0xcccd, v2
    v_lshrrev_b32 v3, 19, v3
    v_mul_u32_u24 v4, 10, v3
    v_sub_u32 v4, v2, v4
    v_mul_u32_u24 v3, 1280, v3
    v_lshl_add_u32 v249, v4, 4, v3
    v_subrev_u32 v249, 3072, v249
    v_add_u32 v2, 256, v1
    v_mul_u32_u24 v3, 0xcccd, v2
    v_lshrrev_b32 v3, 19, v3
    v_mul_u32_u24 v4, 10, v3
    v_sub_u32 v4, v2, v4
    v_mul_u32_u24 v3, 1280, v3
    v_lshl_add_u32 v250, v4, 4, v3
    s_barrier
    s_lshl_b32 s15, s36, 4
    s_add_u32 s15, s15, s37
    s_lshl_b32 s15, s15, 2
    s_add_u32 s15, s15, s12
    s_lshl_b32 s15, s15, 7
    s_add_u32 s15, s15, 22151168
    v_mov_b32 v7, s13
    s_add_u32 s16, s12, 0
    s_and_b32 s16, s16, 3
    s_mul_i32 s16, s16, 49152
    v_add_u32 v240, s16, v8
    s_add_u32 s16, s12, 1
    s_and_b32 s16, s16, 3
    s_mul_i32 s16, s16, 49152
    v_add_u32 v241, s16, v8
    s_add_u32 s16, s12, 2
    s_and_b32 s16, s16, 3
    s_mul_i32 s16, s16, 49152
    v_add_u32 v242, s16, v8
    s_add_u32 s16, s12, 3
    s_and_b32 s16, s16, 3
    s_mul_i32 s16, s16, 49152
    v_add_u32 v243, s16, v8
    v_lshrrev_b32 v3, 2, v1
    v_mul_u32_u24 v3, 160, v3
    v_add_u32 v3, s45, v3
    v_and_b32 v4, 3, v1
    v_lshl_add_u32 v251, v4, 4, v3
    v_lshl_add_u32 v252, v4, 3, v3
    s_add_u32 m0, s45, 0
    s_add_u32 s44, s47, 0
    buffer_load_dwordx4 v246, s[52:55], s44 offen offset:0 lds
    buffer_load_dwordx4 v247, s[52:55], s44 offen offset:1024 lds
    buffer_load_dwordx4 v248, s[52:55], s44 offen offset:2048 lds
    buffer_load_dwordx4 v249, s[52:55], s44 offen offset:3072 lds
    s_add_u32 m0, s45, 4096
    s_nop 0
    buffer_load_dwordx4 v250, s[52:55], s44 offen offset:0 lds
    s_add_u32 m0, s45, 5120
    s_add_u32 s44, s47, 40960
    buffer_load_dwordx4 v246, s[52:55], s44 offen offset:0 lds
    buffer_load_dwordx4 v247, s[52:55], s44 offen offset:1024 lds
    buffer_load_dwordx4 v248, s[52:55], s44 offen offset:2048 lds
    buffer_load_dwordx4 v249, s[52:55], s44 offen offset:3072 lds
    s_add_u32 m0, s45, 9216
    s_nop 0
    buffer_load_dwordx4 v250, s[52:55], s44 offen offset:0 lds
    v_and_b32 v2, 3, v1
    v_bfe_u32 v3, v1, 2, 1
    v_lshl_add_u32 v9, v2, 2, v3
    v_lshlrev_b32 v9, 7, v9
    s_lshr_b32 s49, s38, 1
    s_lshl_b32 s49, s49, 2
    s_add_u32 s49, s49, s12
    s_lshl_b32 s49, s49, 3
    s_and_b32 s16, s38, 1
    s_add_u32 s49, s49, s16
    s_lshl_b32 s49, s49, 8
    s_add_u32 s49, s49, 22151168
    v_mul_u32_u24 v2, 49152, v2
    v_lshrrev_b32 v3, 2, v1
    v_lshl_add_u32 v2, v3, 10, v2
    s_lshl_b32 s16, s39, 7
    s_add_u32 s16, s16, s48
    s_waitcnt vmcnt(10)
    s_mov_b64 exec, 1
    buffer_store_dword v7, v6, s[4:7], s15 offen sc1
    s_mov_b64 exec, -1
    s_setprio 0
    s_add_u32 m0, s45, 10240
    s_add_u32 s44, s47, 81920
    buffer_load_dwordx4 v246, s[52:55], s44 offen offset:0 lds
    buffer_load_dwordx4 v247, s[52:55], s44 offen offset:1024 lds
    buffer_load_dwordx4 v248, s[52:55], s44 offen offset:2048 lds
    buffer_load_dwordx4 v249, s[52:55], s44 offen offset:3072 lds
    s_add_u32 m0, s45, 14336
    s_nop 0
    buffer_load_dwordx4 v250, s[52:55], s44 offen offset:0 lds
    s_add_u32 m0, s45, 15360
    s_add_u32 s44, s47, 122880
    buffer_load_dwordx4 v246, s[52:55], s44 offen offset:0 lds
    buffer_load_dwordx4 v247, s[52:55], s44 offen offset:1024 lds
    buffer_load_dwordx4 v248, s[52:55], s44 offen offset:2048 lds
    buffer_load_dwordx4 v249, s[52:55], s44 offen offset:3072 lds
    s_add_u32 m0, s45, 19456
    s_nop 0
    buffer_load_dwordx4 v250, s[52:55], s44 offen offset:0 lds
    s_waitcnt vmcnt(16)
    ds_read_b64_tr_b16 v[12:13], v251 offset:0
    ds_read_b64_tr_b16 v[14:15], v251 offset:2560
    ds_read_b64_tr_b16 v[16:17], v251 offset:8
    ds_read_b64_tr_b16 v[18:19], v251 offset:2568
    ds_read_b64_tr_b16 v[20:21], v251 offset:64
    ds_read_b64_tr_b16 v[22:23], v251 offset:2624
    ds_read_b64_tr_b16 v[24:25], v251 offset:72
    ds_read_b64_tr_b16 v[26:27], v251 offset:2632
    ds_read_b64_tr_b16 v[28:29], v252 offset:128
    ds_read_b64_tr_b16 v[30:31], v252 offset:2688
    s_waitcnt vmcnt(11)
    ds_read_b64_tr_b16 v[32:33], v251 offset:5120
    ds_read_b64_tr_b16 v[34:35], v251 offset:7680
    ds_read_b64_tr_b16 v[36:37], v251 offset:5128
    ds_read_b64_tr_b16 v[38:39], v251 offset:7688
    ds_read_b64_tr_b16 v[40:41], v251 offset:5184
    ds_read_b64_tr_b16 v[42:43], v251 offset:7744
    ds_read_b64_tr_b16 v[44:45], v251 offset:5192
    ds_read_b64_tr_b16 v[46:47], v251 offset:7752
    ds_read_b64_tr_b16 v[48:49], v252 offset:5248
    ds_read_b64_tr_b16 v[50:51], v252 offset:7808
    s_waitcnt lgkmcnt(10)
    s_add_u32 m0, s45, 0
    s_add_u32 s44, s47, 163840
    buffer_load_dwordx4 v246, s[52:55], s44 offen offset:0 lds
    buffer_load_dwordx4 v247, s[52:55], s44 offen offset:1024 lds
    buffer_load_dwordx4 v248, s[52:55], s44 offen offset:2048 lds
    buffer_load_dwordx4 v249, s[52:55], s44 offen offset:3072 lds
    s_add_u32 m0, s45, 4096
    s_nop 0
    buffer_load_dwordx4 v250, s[52:55], s44 offen offset:0 lds
    s_waitcnt vmcnt(10)
    ds_read_b64_tr_b16 v[52:53], v251 offset:10240
    ds_read_b64_tr_b16 v[54:55], v251 offset:12800
    ds_read_b64_tr_b16 v[56:57], v251 offset:10248
    ds_read_b64_tr_b16 v[58:59], v251 offset:12808
    ds_read_b64_tr_b16 v[60:61], v251 offset:10304
    ds_read_b64_tr_b16 v[62:63], v251 offset:12864
    ds_read_b64_tr_b16 v[64:65], v251 offset:10312
    ds_read_b64_tr_b16 v[66:67], v251 offset:12872
    ds_read_b64_tr_b16 v[68:69], v252 offset:10368
    ds_read_b64_tr_b16 v[70:71], v252 offset:12928
    s_waitcnt lgkmcnt(10)
    s_add_u32 m0, s45, 5120
    s_add_u32 s44, s47, 204800
    buffer_load_dwordx4 v246, s[52:55], s44 offen offset:0 lds
    buffer_load_dwordx4 v247, s[52:55], s44 offen offset:1024 lds
    buffer_load_dwordx4 v248, s[52:55], s44 offen offset:2048 lds
    buffer_load_dwordx4 v249, s[52:55], s44 offen offset:3072 lds
    s_add_u32 m0, s45, 9216
    s_nop 0
    buffer_load_dwordx4 v250, s[52:55], s44 offen offset:0 lds
    s_waitcnt vmcnt(10)
    ds_read_b64_tr_b16 v[72:73], v251 offset:15360
    ds_read_b64_tr_b16 v[74:75], v251 offset:17920
    ds_read_b64_tr_b16 v[76:77], v251 offset:15368
    ds_read_b64_tr_b16 v[78:79], v251 offset:17928
    ds_read_b64_tr_b16 v[80:81], v251 offset:15424
    ds_read_b64_tr_b16 v[82:83], v251 offset:17984
    ds_read_b64_tr_b16 v[84:85], v251 offset:15432
    ds_read_b64_tr_b16 v[86:87], v251 offset:17992
    ds_read_b64_tr_b16 v[88:89], v252 offset:15488
    ds_read_b64_tr_b16 v[90:91], v252 offset:18048
    s_waitcnt lgkmcnt(10)
    s_add_u32 m0, s45, 10240
    s_add_u32 s44, s47, 245760
    buffer_load_dwordx4 v246, s[52:55], s44 offen offset:0 lds
    buffer_load_dwordx4 v247, s[52:55], s44 offen offset:1024 lds
    buffer_load_dwordx4 v248, s[52:55], s44 offen offset:2048 lds
    buffer_load_dwordx4 v249, s[52:55], s44 offen offset:3072 lds
    s_add_u32 m0, s45, 14336
    s_nop 0
    buffer_load_dwordx4 v250, s[52:55], s44 offen offset:0 lds
    v_mov_b32 v10, s13
    s_mov_b64 exec, 0xff
    buffer_load_dword v10, v9, s[4:7], s49 offen sc1
    s_mov_b64 exec, -1
    s_waitcnt lgkmcnt(0)
    s_add_u32 m0, s45, 15360
    s_add_u32 s44, s47, 286720
    buffer_load_dwordx4 v246, s[52:55], s44 offen offset:0 lds
    buffer_load_dwordx4 v247, s[52:55], s44 offen offset:1024 lds
    buffer_load_dwordx4 v248, s[52:55], s44 offen offset:2048 lds
    buffer_load_dwordx4 v249, s[52:55], s44 offen offset:3072 lds
    s_add_u32 m0, s45, 19456
    s_nop 0
    buffer_load_dwordx4 v250, s[52:55], s44 offen offset:0 lds
    s_waitcnt vmcnt(5)
    v_cmp_ne_u32 vcc, s13, v10
    s_nop 0
    s_cmp_eq_u64 vcc, 0
    s_cbranch_scc1 FD_5
    s_mov_b32 s14, 0
FL_6:
    s_sleep 3
    s_mov_b64 exec, vcc
    buffer_load_dword v10, v9, s[4:7], s49 offen sc1
    s_mov_b64 exec, -1
    s_waitcnt vmcnt(0)
    v_cmp_ne_u32 vcc, s13, v10
    s_nop 0
    s_cmp_eq_u64 vcc, 0
    s_cbranch_scc1 FD_5
    s_add_u32 s14, s14, 1
    s_cmp_lt_u32 s14, 16384
    s_cbranch_scc1 FL_6
FD_5:
    s_setprio 0
    buffer_load_dwordx4 v[192:195], v240, s[4:7], s48 offen sc1
    buffer_load_dwordx4 v[196:199], v241, s[4:7], s48 offen sc1
    buffer_load_dwordx4 v[200:203], v242, s[4:7], s48 offen sc1
    buffer_load_dwordx4 v[204:207], v243, s[4:7], s48 offen sc1
    s_add_u32 s48, s48, 1024
    buffer_load_dwordx4 v[208:211], v240, s[4:7], s48 offen sc1
    buffer_load_dwordx4 v[212:215], v241, s[4:7], s48 offen sc1
    buffer_load_dwordx4 v[216:219], v242, s[4:7], s48 offen sc1
    buffer_load_dwordx4 v[220:223], v243, s[4:7], s48 offen sc1
    s_add_u32 s48, s48, 1024
    buffer_load_dwordx4 v[224:227], v240, s[4:7], s48 offen sc1
    buffer_load_dwordx4 v[228:231], v241, s[4:7], s48 offen sc1
    buffer_load_dwordx4 v[232:235], v242, s[4:7], s48 offen sc1
    buffer_load_dwordx4 v[236:239], v243, s[4:7], s48 offen sc1
    s_add_u32 s48, s48, 1024
    s_waitcnt vmcnt(28)
    ds_read_b64_tr_b16 v[92:93], v251 offset:0
    ds_read_b64_tr_b16 v[94:95], v251 offset:2560
    ds_read_b64_tr_b16 v[96:97], v251 offset:8
    ds_read_b64_tr_b16 v[98:99], v251 offset:2568
    ds_read_b64_tr_b16 v[100:101], v251 offset:64
    ds_read_b64_tr_b16 v[102:103], v251 offset:2624
    ds_read_b64_tr_b16 v[104:105], v251 offset:72
    ds_read_b64_tr_b16 v[106:107], v251 offset:2632
    ds_read_b64_tr_b16 v[108:109], v252 offset:128
    ds_read_b64_tr_b16 v[110:111], v252 offset:2688
    s_waitcnt lgkmcnt(0)
    s_add_u32 m0, s45, 0
    s_add_u32 s44, s47, 327680
    buffer_load_dwordx4 v246, s[52:55], s44 offen offset:0 lds
    buffer_load_dwordx4 v247, s[52:55], s44 offen offset:1024 lds
    buffer_load_dwordx4 v248, s[52:55], s44 offen offset:2048 lds
    buffer_load_dwordx4 v249, s[52:55], s44 offen offset:3072 lds
    s_add_u32 m0, s45, 4096
    s_nop 0
    buffer_load_dwordx4 v250, s[52:55], s44 offen offset:0 lds
    s_lshl_b32 s40, s38, 6
    s_lshl_b32 s16, s12, 4
    s_add_u32 s40, s40, s16
    s_mul_i32 s40, s40, 1280
    s_mul_i32 s16, s39, 160
    s_add_u32 s40, s40, s16
    v_lshrrev_b32 v2, 3, v1
    v_and_b32 v3, 7, v1
    v_lshlrev_b32 v3, 4, v3
    v_lshl_add_u32 v244, v2, 12, v3
    s_mul_i32 s46, s12, 2560
    v_min_u32 v9, 19, v1
    v_lshlrev_b32 v9, 7, v9
    s_mul_i32 s17, s39, 80
    s_mul_i32 s15, s12, 20
    s_add_u32 s43, s17, s15
    s_lshl_b32 s17, s43, 7
    s_lshr_b32 s15, s38, 3
    s_lshl_b32 s15, s15, 2
    s_add_u32 s17, s17, s15
    s_add_u32 s49, s17, 22413312
    s_waitcnt vmcnt(16)
    v_mfma_f32_16x16x32_bf16 v[112:115], v[12:15], v[192:195], 0
    v_mfma_f32_16x16x32_bf16 v[128:131], v[16:19], v[192:195], 0
    v_mfma_f32_16x16x32_bf16 v[144:147], v[20:23], v[192:195], 0
    v_mfma_f32_16x16x32_bf16 v[160:163], v[24:27], v[192:195], 0
    v_mfma_f32_16x16x32_bf16 v[176:179], v[28:31], v[192:195], 0
    s_waitcnt vmcnt(15)
    v_mfma_f32_16x16x32_bf16 v[116:119], v[12:15], v[196:199], 0
    buffer_load_dwordx4 v[192:195], v240, s[4:7], s48 offen sc1
    v_mfma_f32_16x16x32_bf16 v[132:135], v[16:19], v[196:199], 0
    v_mfma_f32_16x16x32_bf16 v[148:151], v[20:23], v[196:199], 0
    v_mfma_f32_16x16x32_bf16 v[164:167], v[24:27], v[196:199], 0
    v_mfma_f32_16x16x32_bf16 v[180:183], v[28:31], v[196:199], 0
    s_waitcnt vmcnt(15)
    v_mfma_f32_16x16x32_bf16 v[120:123], v[12:15], v[200:203], 0
    buffer_load_dwordx4 v[196:199], v241, s[4:7], s48 offen sc1
    v_mfma_f32_16x16x32_bf16 v[136:139], v[16:19], v[200:203], 0
    v_mfma_f32_16x16x32_bf16 v[152:155], v[20:23], v[200:203], 0
    v_mfma_f32_16x16x32_bf16 v[168:171], v[24:27], v[200:203], 0
    v_mfma_f32_16x16x32_bf16 v[184:187], v[28:31], v[200:203], 0
    s_waitcnt vmcnt(15)
    v_mfma_f32_16x16x32_bf16 v[124:127], v[12:15], v[204:207], 0
    buffer_load_dwordx4 v[200:203], v242, s[4:7], s48 offen sc1
    v_mfma_f32_16x16x32_bf16 v[140:143], v[16:19], v[204:207], 0
    v_mfma_f32_16x16x32_bf16 v[156:159], v[20:23], v[204:207], 0
    v_mfma_f32_16x16x32_bf16 v[172:175], v[24:27], v[204:207], 0
    v_mfma_f32_16x16x32_bf16 v[188:191], v[28:31], v[204:207], 0
    buffer_load_dwordx4 v[204:207], v243, s[4:7], s48 offen sc1
    s_add_u32 s48, s48, 1024
    s_waitcnt vmcnt(16)
    v_mfma_f32_16x16x32_bf16 v[112:115], v[32:35], v[208:211], v[112:115]
    s_waitcnt vmcnt(32)
    ds_read_b64_tr_b16 v[12:13], v251 offset:5120
    ds_read_b64_tr_b16 v[14:15], v251 offset:7680
    v_mfma_f32_16x16x32_bf16 v[128:131], v[36:39], v[208:211], v[128:131]
    ds_read_b64_tr_b16 v[16:17], v251 offset:5128
    ds_read_b64_tr_b16 v[18:19], v251 offset:7688
    v_mfma_f32_16x16x32_bf16 v[144:147], v[40:43], v[208:211], v[144:147]
    ds_read_b64_tr_b16 v[20:21], v251 offset:5184
    ds_read_b64_tr_b16 v[22:23], v251 offset:7744
    v_mfma_f32_16x16x32_bf16 v[160:163], v[44:47], v[208:211], v[160:163]
    ds_read_b64_tr_b16 v[24:25], v251 offset:5192
    ds_read_b64_tr_b16 v[26:27], v251 offset:7752
    v_mfma_f32_16x16x32_bf16 v[176:179], v[48:51], v[208:211], v[176:179]
    ds_read_b64_tr_b16 v[28:29], v252 offset:5248
    ds_read_b64_tr_b16 v[30:31], v252 offset:7808
    s_waitcnt vmcnt(15)
    v_mfma_f32_16x16x32_bf16 v[116:119], v[32:35], v[212:215], v[116:119]
    buffer_load_dwordx4 v[208:211], v240, s[4:7], s48 offen sc1
    v_mfma_f32_16x16x32_bf16 v[132:135], v[36:39], v[212:215], v[132:135]
    v_mfma_f32_16x16x32_bf16 v[148:151], v[40:43], v[212:215], v[148:151]
    v_mfma_f32_16x16x32_bf16 v[164:167], v[44:47], v[212:215], v[164:167]
    v_mfma_f32_16x16x32_bf16 v[180:183], v[48:51], v[212:215], v[180:183]
    s_waitcnt vmcnt(15)
    s_waitcnt lgkmcnt(0)
    v_mfma_f32_16x16x32_bf16 v[120:123], v[32:35], v[216:219], v[120:123]
    buffer_load_dwordx4 v[212:215], v241, s[4:7], s48 offen sc1
    v_mfma_f32_16x16x32_bf16 v[136:139], v[36:39], v[216:219], v[136:139]
    s_add_u32 m0, s45, 5120
    s_add_u32 s44, s47, 368640
    buffer_load_dwordx4 v246, s[52:55], s44 offen offset:0 lds
    v_mfma_f32_16x16x32_bf16 v[152:155], v[40:43], v[216:219], v[152:155]
    buffer_load_dwordx4 v247, s[52:55], s44 offen offset:1024 lds
    v_mfma_f32_16x16x32_bf16 v[168:171], v[44:47], v[216:219], v[168:171]
    v_mfma_f32_16x16x32_bf16 v[184:187], v[48:51], v[216:219], v[184:187]
    buffer_load_dwordx4 v248, s[52:55], s44 offen offset:2048 lds
    s_waitcnt vmcnt(18)
    v_mfma_f32_16x16x32_bf16 v[124:127], v[32:35], v[220:223], v[124:127]
    buffer_load_dwordx4 v[216:219], v242, s[4:7], s48 offen sc1
    v_mfma_f32_16x16x32_bf16 v[140:143], v[36:39], v[220:223], v[140:143]
    buffer_load_dwordx4 v249, s[52:55], s44 offen offset:3072 lds
    v_mfma_f32_16x16x32_bf16 v[156:159], v[40:43], v[220:223], v[156:159]
    s_add_u32 m0, s45, 9216
    s_nop 0
    buffer_load_dwordx4 v250, s[52:55], s44 offen offset:0 lds
    v_mfma_f32_16x16x32_bf16 v[172:175], v[44:47], v[220:223], v[172:175]
    v_mfma_f32_16x16x32_bf16 v[188:191], v[48:51], v[220:223], v[188:191]
    buffer_load_dwordx4 v[220:223], v243, s[4:7], s48 offen sc1
    s_add_u32 s48, s48, 1024
    s_waitcnt vmcnt(21)
    v_mfma_f32_16x16x32_bf16 v[112:115], v[52:55], v[224:227], v[112:115]
    s_waitcnt vmcnt(36)
    ds_read_b64_tr_b16 v[32:33], v251 offset:10240
    ds_read_b64_tr_b16 v[34:35], v251 offset:12800
    v_mfma_f32_16x16x32_bf16 v[128:131], v[56:59], v[224:227], v[128:131]
    ds_read_b64_tr_b16 v[36:37], v251 offset:10248
    ds_read_b64_tr_b16 v[38:39], v251 offset:12808
    v_mfma_f32_16x16x32_bf16 v[144:147], v[60:63], v[224:227], v[144:147]
    ds_read_b64_tr_b16 v[40:41], v251 offset:10304
    ds_read_b64_tr_b16 v[42:43], v251 offset:12864
    v_mfma_f32_16x16x32_bf16 v[160:163], v[64:67], v[224:227], v[160:163]
    ds_read_b64_tr_b16 v[44:45], v251 offset:10312
    ds_read_b64_tr_b16 v[46:47], v251 offset:12872
    v_mfma_f32_16x16x32_bf16 v[176:179], v[68:71], v[224:227], v[176:179]
    ds_read_b64_tr_b16 v[48:49], v252 offset:10368
    ds_read_b64_tr_b16 v[50:51], v252 offset:12928
    s_waitcnt vmcnt(20)
    v_mfma_f32_16x16x32_bf16 v[116:119], v[52:55], v[228:231], v[116:119]
    buffer_load_dwordx4 v[224:227], v240, s[4:7], s48 offen sc1
    v_mfma_f32_16x16x32_bf16 v[132:135], v[56:59], v[228:231], v[132:135]
    v_mfma_f32_16x16x32_bf16 v[148:151], v[60:63], v[228:231], v[148:151]
    v_mfma_f32_16x16x32_bf16 v[164:167], v[64:67], v[228:231], v[164:167]
    v_mfma_f32_16x16x32_bf16 v[180:183], v[68:71], v[228:231], v[180:183]
    s_waitcnt vmcnt(20)
    s_waitcnt lgkmcnt(0)
    v_mfma_f32_16x16x32_bf16 v[120:123], v[52:55], v[232:235], v[120:123]
    buffer_load_dwordx4 v[228:231], v241, s[4:7], s48 offen sc1
    v_mfma_f32_16x16x32_bf16 v[136:139], v[56:59], v[232:235], v[136:139]
    s_add_u32 m0, s45, 10240
    s_add_u32 s44, s47, 409600
    buffer_load_dwordx4 v246, s[52:55], s44 offen offset:0 lds
    v_mfma_f32_16x16x32_bf16 v[152:155], v[60:63], v[232:235], v[152:155]
    buffer_load_dwordx4 v247, s[52:55], s44 offen offset:1024 lds
    v_mfma_f32_16x16x32_bf16 v[168:171], v[64:67], v[232:235], v[168:171]
    v_mfma_f32_16x16x32_bf16 v[184:187], v[68:71], v[232:235], v[184:187]
    buffer_load_dwordx4 v248, s[52:55], s44 offen offset:2048 lds
    s_waitcnt vmcnt(23)
    v_mfma_f32_16x16x32_bf16 v[124:127], v[52:55], v[236:239], v[124:127]
    buffer_load_dwordx4 v[232:235], v242, s[4:7], s48 offen sc1
    v_mfma_f32_16x16x32_bf16 v[140:143], v[56:59], v[236:239], v[140:143]
    buffer_load_dwordx4 v249, s[52:55], s44 offen offset:3072 lds
    v_mfma_f32_16x16x32_bf16 v[156:159], v[60:63], v[236:239], v[156:159]
    s_add_u32 m0, s45, 14336
    s_nop 0
    buffer_load_dwordx4 v250, s[52:55], s44 offen offset:0 lds
    v_mfma_f32_16x16x32_bf16 v[172:175], v[64:67], v[236:239], v[172:175]
    v_mfma_f32_16x16x32_bf16 v[188:191], v[68:71], v[236:239], v[188:191]
    buffer_load_dwordx4 v[236:239], v243, s[4:7], s48 offen sc1
    s_add_u32 s48, s48, 1024
    s_waitcnt vmcnt(21)
    v_mfma_f32_16x16x32_bf16 v[112:115], v[72:75], v[192:195], v[112:115]
    s_waitcnt vmcnt(39)
    ds_read_b64_tr_b16 v[52:53], v251 offset:15360
    ds_read_b64_tr_b16 v[54:55], v251 offset:17920
    v_mfma_f32_16x16x32_bf16 v[128:131], v[76:79], v[192:195], v[128:131]
    ds_read_b64_tr_b16 v[56:57], v251 offset:15368
    ds_read_b64_tr_b16 v[58:59], v251 offset:17928
    v_mfma_f32_16x16x32_bf16 v[144:147], v[80:83], v[192:195], v[144:147]
    ds_read_b64_tr_b16 v[60:61], v251 offset:15424
    ds_read_b64_tr_b16 v[62:63], v251 offset:17984
    v_mfma_f32_16x16x32_bf16 v[160:163], v[84:87], v[192:195], v[160:163]
    ds_read_b64_tr_b16 v[64:65], v251 offset:15432
    ds_read_b64_tr_b16 v[66:67], v251 offset:17992
    v_mfma_f32_16x16x32_bf16 v[176:179], v[88:91], v[192:195], v[176:179]
    ds_read_b64_tr_b16 v[68:69], v252 offset:15488
    ds_read_b64_tr_b16 v[70:71], v252 offset:18048
    s_waitcnt vmcnt(20)
    v_mfma_f32_16x16x32_bf16 v[116:119], v[72:75], v[196:199], v[116:119]
    buffer_load_dwordx4 v[192:195], v240, s[4:7], s48 offen sc1
    v_mfma_f32_16x16x32_bf16 v[132:135], v[76:79], v[196:199], v[132:135]
    v_mfma_f32_16x16x32_bf16 v[148:151], v[80:83], v[196:199], v[148:151]
    v_mfma_f32_16x16x32_bf16 v[164:167], v[84:87], v[196:199], v[164:167]
    v_mfma_f32_16x16x32_bf16 v[180:183], v[88:91], v[196:199], v[180:183]
    s_waitcnt vmcnt(20)
    s_waitcnt lgkmcnt(0)
    v_mfma_f32_16x16x32_bf16 v[120:123], v[72:75], v[200:203], v[120:123]
    buffer_load_dwordx4 v[196:199], v241, s[4:7], s48 offen sc1
    v_mfma_f32_16x16x32_bf16 v[136:139], v[76:79], v[200:203], v[136:139]
    s_add_u32 m0, s45, 15360
    s_add_u32 s44, s47, 450560
    buffer_load_dwordx4 v246, s[52:55], s44 offen offset:0 lds
    v_mfma_f32_16x16x32_bf16 v[152:155], v[80:83], v[200:203], v[152:155]
    buffer_load_dwordx4 v247, s[52:55], s44 offen offset:1024 lds
    v_mfma_f32_16x16x32_bf16 v[168:171], v[84:87], v[200:203], v[168:171]
    v_mfma_f32_16x16x32_bf16 v[184:187], v[88:91], v[200:203], v[184:187]
    buffer_load_dwordx4 v248, s[52:55], s44 offen offset:2048 lds
    s_waitcnt vmcnt(23)
    v_mfma_f32_16x16x32_bf16 v[124:127], v[72:75], v[204:207], v[124:127]
    buffer_load_dwordx4 v[200:203], v242, s[4:7], s48 offen sc1
    v_mfma_f32_16x16x32_bf16 v[140:143], v[76:79], v[204:207], v[140:143]
    buffer_load_dwordx4 v249, s[52:55], s44 offen offset:3072 lds
    v_mfma_f32_16x16x32_bf16 v[156:159], v[80:83], v[204:207], v[156:159]
    s_add_u32 m0, s45, 19456
    s_nop 0
    buffer_load_dwordx4 v250, s[52:55], s44 offen offset:0 lds
    v_mfma_f32_16x16x32_bf16 v[172:175], v[84:87], v[204:207], v[172:175]
    v_mfma_f32_16x16x32_bf16 v[188:191], v[88:91], v[204:207], v[188:191]
    buffer_load_dwordx4 v[204:207], v243, s[4:7], s48 offen sc1
    s_add_u32 s48, s48, 1024
    s_waitcnt lgkmcnt(15)
    s_waitcnt vmcnt(26)
    v_mfma_f32_16x16x32_bf16 v[112:115], v[92:95], v[208:211], v[112:115]
    s_waitcnt vmcnt(31)
    ds_read_b64_tr_b16 v[72:73], v251 offset:0
    ds_read_b64_tr_b16 v[74:75], v251 offset:2560
    v_mfma_f32_16x16x32_bf16 v[128:131], v[96:99], v[208:211], v[128:131]
    ds_read_b64_tr_b16 v[76:77], v251 offset:8
    ds_read_b64_tr_b16 v[78:79], v251 offset:2568
    v_mfma_f32_16x16x32_bf16 v[144:147], v[100:103], v[208:211], v[144:147]
    ds_read_b64_tr_b16 v[80:81], v251 offset:64
    ds_read_b64_tr_b16 v[82:83], v251 offset:2624
    v_mfma_f32_16x16x32_bf16 v[160:163], v[104:107], v[208:211], v[160:163]
    ds_read_b64_tr_b16 v[84:85], v251 offset:72
    ds_read_b64_tr_b16 v[86:87], v251 offset:2632
    v_mfma_f32_16x16x32_bf16 v[176:179], v[108:111], v[208:211], v[176:179]
    ds_read_b64_tr_b16 v[88:89], v252 offset:128
    ds_read_b64_tr_b16 v[90:91], v252 offset:2688
    s_waitcnt vmcnt(25)
    v_mfma_f32_16x16x32_bf16 v[116:119], v[92:95], v[212:215], v[116:119]
    buffer_load_dwordx4 v[208:211], v240, s[4:7], s48 offen sc1
    v_mfma_f32_16x16x32_bf16 v[132:135], v[96:99], v[212:215], v[132:135]
    v_mfma_f32_16x16x32_bf16 v[148:151], v[100:103], v[212:215], v[148:151]
    v_mfma_f32_16x16x32_bf16 v[164:167], v[104:107], v[212:215], v[164:167]
    v_mfma_f32_16x16x32_bf16 v[180:183], v[108:111], v[212:215], v[180:183]
    s_waitcnt vmcnt(22)
    v_mfma_f32_16x16x32_bf16 v[120:123], v[92:95], v[216:219], v[120:123]
    buffer_load_dwordx4 v[212:215], v241, s[4:7], s48 offen sc1
    v_mfma_f32_16x16x32_bf16 v[136:139], v[96:99], v[216:219], v[136:139]
    v_mfma_f32_16x16x32_bf16 v[152:155], v[100:103], v[216:219], v[152:155]
    v_mfma_f32_16x16x32_bf16 v[168:171], v[104:107], v[216:219], v[168:171]
    v_mfma_f32_16x16x32_bf16 v[184:187], v[108:111], v[216:219], v[184:187]
    s_waitcnt vmcnt(20)
    v_mfma_f32_16x16x32_bf16 v[124:127], v[92:95], v[220:223], v[124:127]
    buffer_load_dwordx4 v[216:219], v242, s[4:7], s48 offen sc1
    v_mfma_f32_16x16x32_bf16 v[140:143], v[96:99], v[220:223], v[140:143]
    v_mfma_f32_16x16x32_bf16 v[156:159], v[100:103], v[220:223], v[156:159]
    v_mfma_f32_16x16x32_bf16 v[172:175], v[104:107], v[220:223], v[172:175]
    v_mfma_f32_16x16x32_bf16 v[188:191], v[108:111], v[220:223], v[188:191]
    buffer_load_dwordx4 v[220:223], v243, s[4:7], s48 offen sc1
    s_add_u32 s48, s48, 1024
    s_waitcnt lgkmcnt(15)
    s_waitcnt vmcnt(21)
    v_mfma_f32_16x16x32_bf16 v[112:115], v[12:15], v[224:227], v[112:115]
    s_waitcnt vmcnt(23)
    ds_read_b64_tr_b16 v[92:93], v251 offset:5120
    ds_read_b64_tr_b16 v[94:95], v251 offset:7680
    v_mfma_f32_16x16x32_bf16 v[128:131], v[16:19], v[224:227], v[128:131]
    ds_read_b64_tr_b16 v[96:97], v251 offset:5128
    ds_read_b64_tr_b16 v[98:99], v251 offset:7688
    v_mfma_f32_16x16x32_bf16 v[144:147], v[20:23], v[224:227], v[144:147]
    ds_read_b64_tr_b16 v[100:101], v251 offset:5184
    ds_read_b64_tr_b16 v[102:103], v251 offset:7744
    v_mfma_f32_16x16x32_bf16 v[160:163], v[24:27], v[224:227], v[160:163]
    ds_read_b64_tr_b16 v[104:105], v251 offset:5192
    ds_read_b64_tr_b16 v[106:107], v251 offset:7752
    v_mfma_f32_16x16x32_bf16 v[176:179], v[28:31], v[224:227], v[176:179]
    ds_read_b64_tr_b16 v[108:109], v252 offset:5248
    ds_read_b64_tr_b16 v[110:111], v252 offset:7808
    s_waitcnt vmcnt(20)
    v_mfma_f32_16x16x32_bf16 v[116:119], v[12:15], v[228:231], v[116:119]
    buffer_load_dwordx4 v[224:227], v240, s[4:7], s48 offen sc1
    v_mfma_f32_16x16x32_bf16 v[132:135], v[16:19], v[228:231], v[132:135]
    v_mfma_f32_16x16x32_bf16 v[148:151], v[20:23], v[228:231], v[148:151]
    v_mfma_f32_16x16x32_bf16 v[164:167], v[24:27], v[228:231], v[164:167]
    v_mfma_f32_16x16x32_bf16 v[180:183], v[28:31], v[228:231], v[180:183]
    s_waitcnt vmcnt(17)
    v_mfma_f32_16x16x32_bf16 v[120:123], v[12:15], v[232:235], v[120:123]
    buffer_load_dwordx4 v[228:231], v241, s[4:7], s48 offen sc1
    v_mfma_f32_16x16x32_bf16 v[136:139], v[16:19], v[232:235], v[136:139]
    v_mfma_f32_16x16x32_bf16 v[152:155], v[20:23], v[232:235], v[152:155]
    v_mfma_f32_16x16x32_bf16 v[168:171], v[24:27], v[232:235], v[168:171]
    v_mfma_f32_16x16x32_bf16 v[184:187], v[28:31], v[232:235], v[184:187]
    s_waitcnt vmcnt(15)
    v_mfma_f32_16x16x32_bf16 v[124:127], v[12:15], v[236:239], v[124:127]
    buffer_load_dwordx4 v[232:235], v242, s[4:7], s48 offen sc1
    v_mfma_f32_16x16x32_bf16 v[140:143], v[16:19], v[236:239], v[140:143]
    v_mfma_f32_16x16x32_bf16 v[156:159], v[20:23], v[236:239], v[156:159]
    v_mfma_f32_16x16x32_bf16 v[172:175], v[24:27], v[236:239], v[172:175]
    v_mfma_f32_16x16x32_bf16 v[188:191], v[28:31], v[236:239], v[188:191]
    buffer_load_dwordx4 v[236:239], v243, s[4:7], s48 offen sc1
    s_add_u32 s48, s48, 1024
    s_waitcnt lgkmcnt(15)
    s_waitcnt vmcnt(16)
    v_mfma_f32_16x16x32_bf16 v[112:115], v[32:35], v[192:195], v[112:115]
    s_waitcnt vmcnt(18)
    ds_read_b64_tr_b16 v[12:13], v251 offset:10240
    ds_read_b64_tr_b16 v[14:15], v251 offset:12800
    v_mfma_f32_16x16x32_bf16 v[128:131], v[36:39], v[192:195], v[128:131]
    ds_read_b64_tr_b16 v[16:17], v251 offset:10248
    ds_read_b64_tr_b16 v[18:19], v251 offset:12808
    v_mfma_f32_16x16x32_bf16 v[144:147], v[40:43], v[192:195], v[144:147]
    ds_read_b64_tr_b16 v[20:21], v251 offset:10304
    ds_read_b64_tr_b16 v[22:23], v251 offset:12864
    v_mfma_f32_16x16x32_bf16 v[160:163], v[44:47], v[192:195], v[160:163]
    ds_read_b64_tr_b16 v[24:25], v251 offset:10312
    ds_read_b64_tr_b16 v[26:27], v251 offset:12872
    v_mfma_f32_16x16x32_bf16 v[176:179], v[48:51], v[192:195], v[176:179]
    ds_read_b64_tr_b16 v[28:29], v252 offset:10368
    ds_read_b64_tr_b16 v[30:31], v252 offset:12928
    s_waitcnt vmcnt(15)
    v_mfma_f32_16x16x32_bf16 v[116:119], v[32:35], v[196:199], v[116:119]
    buffer_load_dwordx4 v[192:195], v240, s[4:7], s48 offen sc1
    v_mfma_f32_16x16x32_bf16 v[132:135], v[36:39], v[196:199], v[132:135]
    v_mfma_f32_16x16x32_bf16 v[148:151], v[40:43], v[196:199], v[148:151]
    v_mfma_f32_16x16x32_bf16 v[164:167], v[44:47], v[196:199], v[164:167]
    v_mfma_f32_16x16x32_bf16 v[180:183], v[48:51], v[196:199], v[180:183]
    s_waitcnt vmcnt(12)
    v_mfma_f32_16x16x32_bf16 v[120:123], v[32:35], v[200:203], v[120:123]
    buffer_load_dwordx4 v[196:199], v241, s[4:7], s48 offen sc1
    v_mfma_f32_16x16x32_bf16 v[136:139], v[36:39], v[200:203], v[136:139]
    v_mfma_f32_16x16x32_bf16 v[152:155], v[40:43], v[200:203], v[152:155]
    v_mfma_f32_16x16x32_bf16 v[168:171], v[44:47], v[200:203], v[168:171]
    v_mfma_f32_16x16x32_bf16 v[184:187], v[48:51], v[200:203], v[184:187]
    s_waitcnt vmcnt(10)
    v_mfma_f32_16x16x32_bf16 v[124:127], v[32:35], v[204:207], v[124:127]
    buffer_load_dwordx4 v[200:203], v242, s[4:7], s48 offen sc1
    v_mfma_f32_16x16x32_bf16 v[140:143], v[36:39], v[204:207], v[140:143]
    v_mfma_f32_16x16x32_bf16 v[156:159], v[40:43], v[204:207], v[156:159]
    v_mfma_f32_16x16x32_bf16 v[172:175], v[44:47], v[204:207], v[172:175]
    v_mfma_f32_16x16x32_bf16 v[188:191], v[48:51], v[204:207], v[188:191]
    buffer_load_dwordx4 v[204:207], v243, s[4:7], s48 offen sc1
    s_add_u32 s48, s48, 1024
    v_mov_b32 v10, s13
    s_mov_b64 exec, 0xfffff
    buffer_load_dword v10, v9, s[4:7], s49 offen sc1
    s_mov_b64 exec, -1
    s_waitcnt lgkmcnt(15)
    s_waitcnt vmcnt(12)
    v_mfma_f32_16x16x32_bf16 v[112:115], v[52:55], v[208:211], v[112:115]
    s_waitcnt vmcnt(14)
    ds_read_b64_tr_b16 v[32:33], v251 offset:15360
    ds_read_b64_tr_b16 v[34:35], v251 offset:17920
    v_mfma_f32_16x16x32_bf16 v[128:131], v[56:59], v[208:211], v[128:131]
    ds_read_b64_tr_b16 v[36:37], v251 offset:15368
    ds_read_b64_tr_b16 v[38:39], v251 offset:17928
    v_mfma_f32_16x16x32_bf16 v[144:147], v[60:63], v[208:211], v[144:147]
    ds_read_b64_tr_b16 v[40:41], v251 offset:15424
    ds_read_b64_tr_b16 v[42:43], v251 offset:17984
    v_mfma_f32_16x16x32_bf16 v[160:163], v[64:67], v[208:211], v[160:163]
    ds_read_b64_tr_b16 v[44:45], v251 offset:15432
    ds_read_b64_tr_b16 v[46:47], v251 offset:17992
    v_mfma_f32_16x16x32_bf16 v[176:179], v[68:71], v[208:211], v[176:179]
    ds_read_b64_tr_b16 v[48:49], v252 offset:15488
    ds_read_b64_tr_b16 v[50:51], v252 offset:18048
    s_waitcnt vmcnt(11)
    v_mfma_f32_16x16x32_bf16 v[116:119], v[52:55], v[212:215], v[116:119]
    buffer_load_dwordx4 v[208:211], v240, s[4:7], s48 offen sc1
    v_mfma_f32_16x16x32_bf16 v[132:135], v[56:59], v[212:215], v[132:135]
    v_mfma_f32_16x16x32_bf16 v[148:151], v[60:63], v[212:215], v[148:151]
    v_mfma_f32_16x16x32_bf16 v[164:167], v[64:67], v[212:215], v[164:167]
    v_mfma_f32_16x16x32_bf16 v[180:183], v[68:71], v[212:215], v[180:183]
    s_waitcnt vmcnt(11)
    v_mfma_f32_16x16x32_bf16 v[120:123], v[52:55], v[216:219], v[120:123]
    buffer_load_dwordx4 v[212:215], v241, s[4:7], s48 offen sc1
    v_mfma_f32_16x16x32_bf16 v[136:139], v[56:59], v[216:219], v[136:139]
    v_mfma_f32_16x16x32_bf16 v[152:155], v[60:63], v[216:219], v[152:155]
    v_mfma_f32_16x16x32_bf16 v[168:171], v[64:67], v[216:219], v[168:171]
    v_mfma_f32_16x16x32_bf16 v[184:187], v[68:71], v[216:219], v[184:187]
    s_waitcnt vmcnt(11)
    v_mfma_f32_16x16x32_bf16 v[124:127], v[52:55], v[220:223], v[124:127]
    buffer_load_dwordx4 v[216:219], v242, s[4:7], s48 offen sc1
    v_mfma_f32_16x16x32_bf16 v[140:143], v[56:59], v[220:223], v[140:143]
    v_mfma_f32_16x16x32_bf16 v[156:159], v[60:63], v[220:223], v[156:159]
    v_mfma_f32_16x16x32_bf16 v[172:175], v[64:67], v[220:223], v[172:175]
    v_mfma_f32_16x16x32_bf16 v[188:191], v[68:71], v[220:223], v[188:191]
    buffer_load_dwordx4 v[220:223], v243, s[4:7], s48 offen sc1
    s_add_u32 s48, s48, 1024
    s_waitcnt lgkmcnt(0)
    s_barrier
    s_add_u32 m0, s46, 71680
    s_nop 0
    buffer_load_dwordx4 v246, s[20:23], s40 offen offset:0 lds
    buffer_load_dwordx4 v247, s[20:23], s40 offen offset:1024 lds
    s_mov_b32 exec_hi, 0
    buffer_load_dwordx4 v248, s[20:23], s40 offen offset:2048 lds
    s_mov_b32 exec_hi, -1
    s_waitcnt lgkmcnt(15)
    s_waitcnt vmcnt(15)
    v_mfma_f32_16x16x32_bf16 v[112:115], v[72:75], v[224:227], v[112:115]
    v_mfma_f32_16x16x32_bf16 v[128:131], v[76:79], v[224:227], v[128:131]
    v_mfma_f32_16x16x32_bf16 v[144:147], v[80:83], v[224:227], v[144:147]
    v_mfma_f32_16x16x32_bf16 v[160:163], v[84:87], v[224:227], v[160:163]
    v_mfma_f32_16x16x32_bf16 v[176:179], v[88:91], v[224:227], v[176:179]
    s_waitcnt vmcnt(14)
    v_mfma_f32_16x16x32_bf16 v[116:119], v[72:75], v[228:231], v[116:119]
    buffer_load_dwordx4 v[224:227], v240, s[4:7], s48 offen sc1
    v_mfma_f32_16x16x32_bf16 v[132:135], v[76:79], v[228:231], v[132:135]
    v_mfma_f32_16x16x32_bf16 v[148:151], v[80:83], v[228:231], v[148:151]
    v_mfma_f32_16x16x32_bf16 v[164:167], v[84:87], v[228:231], v[164:167]
    v_mfma_f32_16x16x32_bf16 v[180:183], v[88:91], v[228:231], v[180:183]
    s_waitcnt vmcnt(14)
    v_mfma_f32_16x16x32_bf16 v[120:123], v[72:75], v[232:235], v[120:123]
    buffer_load_dwordx4 v[228:231], v241, s[4:7], s48 offen sc1
    v_mfma_f32_16x16x32_bf16 v[136:139], v[76:79], v[232:235], v[136:139]
    v_mfma_f32_16x16x32_bf16 v[152:155], v[80:83], v[232:235], v[152:155]
    v_mfma_f32_16x16x32_bf16 v[168:171], v[84:87], v[232:235], v[168:171]
    v_mfma_f32_16x16x32_bf16 v[184:187], v[88:91], v[232:235], v[184:187]
    s_waitcnt vmcnt(14)
    v_mfma_f32_16x16x32_bf16 v[124:127], v[72:75], v[236:239], v[124:127]
    buffer_load_dwordx4 v[232:235], v242, s[4:7], s48 offen sc1
    v_mfma_f32_16x16x32_bf16 v[140:143], v[76:79], v[236:239], v[140:143]
    v_mfma_f32_16x16x32_bf16 v[156:159], v[80:83], v[236:239], v[156:159]
    v_mfma_f32_16x16x32_bf16 v[172:175], v[84:87], v[236:239], v[172:175]
    v_mfma_f32_16x16x32_bf16 v[188:191], v[88:91], v[236:239], v[188:191]
    buffer_load_dwordx4 v[236:239], v243, s[4:7], s48 offen sc1
    s_waitcnt vmcnt(11)
    v_cmp_ne_u32 vcc, s13, v10
    s_nop 0
    s_cmp_eq_u64 vcc, 0
    s_cbranch_scc1 FD_7
    s_mov_b32 s14, 0
FL_8:
    s_sleep 8
    s_mov_b64 exec, vcc
    buffer_load_dword v10, v9, s[4:7], s49 offen sc1
    s_mov_b64 exec, -1
    s_waitcnt vmcnt(0)
    v_cmp_ne_u32 vcc, s13, v10
    s_nop 0
    s_cmp_eq_u64 vcc, 0
    s_cbranch_scc1 FD_7
    s_add_u32 s14, s14, 1
    s_cmp_lt_u32 s14, 16384
    s_cbranch_scc1 FL_8
FD_7:
    s_lshl_b32 s15, s43, 12
    s_lshl_b32 s16, s38, 7
    s_add_u32 s15, s15, s16
    s_add_u32 s15, s15, 4194304
    s_add_u32 m0, s46, 61440
    s_nop 0
    buffer_load_dwordx4 v244, s[4:7], s15 offen sc1 lds
    s_add_u32 s15, s15, 32768
    s_add_u32 m0, s46, 62464
    s_nop 0
    buffer_load_dwordx4 v244, s[4:7], s15 offen sc1 lds
    s_add_u32 s15, s15, 32768
    s_mov_b32 exec_hi, 0
    s_add_u32 m0, s46, 63488
    s_nop 0
    buffer_load_dwordx4 v244, s[4:7], s15 offen sc1 lds
    s_mov_b32 exec_hi, -1
    s_waitcnt lgkmcnt(15)
    s_waitcnt vmcnt(18)
    v_mfma_f32_16x16x32_bf16 v[112:115], v[92:95], v[192:195], v[112:115]
    v_mfma_f32_16x16x32_bf16 v[128:131], v[96:99], v[192:195], v[128:131]
    v_mfma_f32_16x16x32_bf16 v[144:147], v[100:103], v[192:195], v[144:147]
    v_mfma_f32_16x16x32_bf16 v[160:163], v[104:107], v[192:195], v[160:163]
    v_mfma_f32_16x16x32_bf16 v[176:179], v[108:111], v[192:195], v[176:179]
    s_waitcnt vmcnt(17)
    v_mfma_f32_16x16x32_bf16 v[116:119], v[92:95], v[196:199], v[116:119]
    v_mfma_f32_16x16x32_bf16 v[132:135], v[96:99], v[196:199], v[132:135]
    v_mfma_f32_16x16x32_bf16 v[148:151], v[100:103], v[196:199], v[148:151]
    v_mfma_f32_16x16x32_bf16 v[164:167], v[104:107], v[196:199], v[164:167]
    v_mfma_f32_16x16x32_bf16 v[180:183], v[108:111], v[196:199], v[180:183]
    s_waitcnt vmcnt(16)
    v_mfma_f32_16x16x32_bf16 v[120:123], v[92:95], v[200:203], v[120:123]
    v_mfma_f32_16x16x32_bf16 v[136:139], v[96:99], v[200:203], v[136:139]
    v_mfma_f32_16x16x32_bf16 v[152:155], v[100:103], v[200:203], v[152:155]
    v_mfma_f32_16x16x32_bf16 v[168:171], v[104:107], v[200:203], v[168:171]
    v_mfma_f32_16x16x32_bf16 v[184:187], v[108:111], v[200:203], v[184:187]
    s_waitcnt vmcnt(15)
    v_mfma_f32_16x16x32_bf16 v[124:127], v[92:95], v[204:207], v[124:127]
    v_mfma_f32_16x16x32_bf16 v[140:143], v[96:99], v[204:207], v[140:143]
    v_mfma_f32_16x16x32_bf16 v[156:159], v[100:103], v[204:207], v[156:159]
    v_mfma_f32_16x16x32_bf16 v[172:175], v[104:107], v[204:207], v[172:175]
    v_mfma_f32_16x16x32_bf16 v[188:191], v[108:111], v[204:207], v[188:191]
    s_waitcnt lgkmcnt(10)
    s_waitcnt vmcnt(13)
    v_mfma_f32_16x16x32_bf16 v[112:115], v[12:15], v[208:211], v[112:115]
    v_mfma_f32_16x16x32_bf16 v[128:131], v[16:19], v[208:211], v[128:131]
    v_mfma_f32_16x16x32_bf16 v[144:147], v[20:23], v[208:211], v[144:147]
    v_mfma_f32_16x16x32_bf16 v[160:163], v[24:27], v[208:211], v[160:163]
    v_mfma_f32_16x16x32_bf16 v[176:179], v[28:31], v[208:211], v[176:179]
    s_waitcnt vmcnt(12)
    v_mfma_f32_16x16x32_bf16 v[116:119], v[12:15], v[212:215], v[116:119]
    v_mfma_f32_16x16x32_bf16 v[132:135], v[16:19], v[212:215], v[132:135]
    v_mfma_f32_16x16x32_bf16 v[148:151], v[20:23], v[212:215], v[148:151]
    v_mfma_f32_16x16x32_bf16 v[164:167], v[24:27], v[212:215], v[164:167]
    v_mfma_f32_16x16x32_bf16 v[180:183], v[28:31], v[212:215], v[180:183]
    s_waitcnt vmcnt(11)
    v_mfma_f32_16x16x32_bf16 v[120:123], v[12:15], v[216:219], v[120:123]
    v_mfma_f32_16x16x32_bf16 v[136:139], v[16:19], v[216:219], v[136:139]
    v_mfma_f32_16x16x32_bf16 v[152:155], v[20:23], v[216:219], v[152:155]
    v_mfma_f32_16x16x32_bf16 v[168:171], v[24:27], v[216:219], v[168:171]
    v_mfma_f32_16x16x32_bf16 v[184:187], v[28:31], v[216:219], v[184:187]
    s_waitcnt vmcnt(10)
    v_mfma_f32_16x16x32_bf16 v[124:127], v[12:15], v[220:223], v[124:127]
    v_mfma_f32_16x16x32_bf16 v[140:143], v[16:19], v[220:223], v[140:143]
    v_mfma_f32_16x16x32_bf16 v[156:159], v[20:23], v[220:223], v[156:159]
    v_mfma_f32_16x16x32_bf16 v[172:175], v[24:27], v[220:223], v[172:175]
    v_mfma_f32_16x16x32_bf16 v[188:191], v[28:31], v[220:223], v[188:191]
    s_add_u32 s16, s12, 1
    s_and_b32 s16, s16, 3
    s_mul_i32 s16, s16, 15360
    v_add_u32 v241, s16, v8
    s_add_u32 s16, s12, 2
    s_and_b32 s16, s16, 3
    s_mul_i32 s16, s16, 15360
    v_add_u32 v242, s16, v8
    s_add_u32 s16, s12, 3
    s_and_b32 s16, s16, 3
    s_mul_i32 s16, s16, 15360
    v_add_u32 v243, s16, v8
    s_waitcnt vmcnt(3)
    s_waitcnt lgkmcnt(0)
    v_mfma_f32_16x16x32_bf16 v[116:119], v[32:35], v[228:231], v[116:119]
    v_lshrrev_b32 v4, 4, v1
    v_mfma_f32_16x16x32_bf16 v[132:135], v[36:39], v[228:231], v[132:135]
    v_bfe_u32 v2, v1, 2, 2
    v_mfma_f32_16x16x32_bf16 v[148:151], v[40:43], v[228:231], v[148:151]
    v_lshl_add_u32 v3, v4, 3, v2
    v_mfma_f32_16x16x32_bf16 v[164:167], v[44:47], v[228:231], v[164:167]
    v_lshl_add_u32 v2, v4, 2, v2
    v_mfma_f32_16x16x32_bf16 v[180:183], v[48:51], v[228:231], v[180:183]
    v_and_b32 v5, 3, v1
    v_mfma_f32_16x16x32_bf16 v[120:123], v[32:35], v[232:235], v[120:123]
    ds_write_b128 v241, v[116:119] offset:0
    v_mfma_f32_16x16x32_bf16 v[136:139], v[36:39], v[232:235], v[136:139]
    ds_write_b128 v241, v[132:135] offset:1024
    v_mfma_f32_16x16x32_bf16 v[152:155], v[40:43], v[232:235], v[152:155]
    ds_write_b128 v241, v[148:151] offset:2048
    v_mfma_f32_16x16x32_bf16 v[168:171], v[44:47], v[232:235], v[168:171]
    ds_write_b128 v241, v[164:167] offset:3072
    v_mfma_f32_16x16x32_bf16 v[184:187], v[48:51], v[232:235], v[184:187]
    ds_write_b128 v241, v[180:183] offset:4096
    v_mfma_f32_16x16x32_bf16 v[124:127], v[32:35], v[236:239], v[124:127]
    ds_write_b128 v242, v[120:123] offset:5120
    v_mfma_f32_16x16x32_bf16 v[140:143], v[36:39], v[236:239], v[140:143]
    ds_write_b128 v242, v[136:139] offset:6144
    v_mfma_f32_16x16x32_bf16 v[156:159], v[40:43], v[236:239], v[156:159]
    ds_write_b128 v242, v[152:155] offset:7168
    v_mfma_f32_16x16x32_bf16 v[172:175], v[44:47], v[236:239], v[172:175]
    ds_write_b128 v242, v[168:171] offset:8192
    v_mfma_f32_16x16x32_bf16 v[188:191], v[48:51], v[236:239], v[188:191]
    ds_write_b128 v242, v[184:187] offset:9216
    v_mfma_f32_16x16x32_bf16 v[112:115], v[32:35], v[224:227], v[112:115]
    ds_write_b128 v243, v[124:127] offset:10240
    v_mfma_f32_16x16x32_bf16 v[128:131], v[36:39], v[224:227], v[128:131]
    ds_write_b128 v243, v[140:143] offset:11264
    v_mfma_f32_16x16x32_bf16 v[144:147], v[40:43], v[224:227], v[144:147]
    ds_write_b128 v243, v[156:159] offset:12288
    v_mfma_f32_16x16x32_bf16 v[160:163], v[44:47], v[224:227], v[160:163]
    ds_write_b128 v243, v[172:175] offset:13312
    v_mfma_f32_16x16x32_bf16 v[176:179], v[48:51], v[224:227], v[176:179]
    ds_write_b128 v243, v[188:191] offset:14336
    s_lshl_b32 s15, s12, 5
    s_add_u32 s15, s15, 61440
    v_lshl_add_u32 v5, v5, 3, s15
    v_lshl_add_u32 v192, v3, 7, v5
    v_lshl_add_u32 v193, v2, 7, v5
    v_and_b32 v2, 15, v1
    v_mul_u32_u24 v2, 160, v2
    s_add_u32 s15, s46, 71680
    v_add_u32 v2, s15, v2
    v_lshl_add_u32 v194, v4, 4, v2
    v_lshl_add_u32 v195, v4, 3, v2
    v_add_u32 v245, s15, v8
    s_mul_i32 s16, s12, 15360
    v_add_u32 v5, s16, v8
    s_mov_b32 s50, 0xbfb8aa3b
    s_mov_b32 s51, 0xbfb8aa3b
    s_waitcnt vmcnt(0) lgkmcnt(0)
    s_barrier
    ds_read_b128 v[116:119], v5 offset:0
    ds_read_b128 v[120:123], v5 offset:5120
    ds_read_b128 v[124:127], v5 offset:10240
    ds_read_b128 v[132:135], v5 offset:1024
    ds_read_b128 v[136:139], v5 offset:6144
    ds_read_b128 v[140:143], v5 offset:11264
    ds_read_b128 v[148:151], v5 offset:2048
    ds_read_b128 v[152:155], v5 offset:7168
    ds_read_b128 v[156:159], v5 offset:12288
    ds_read_b128 v[164:167], v5 offset:3072
    ds_read_b128 v[168:171], v5 offset:8192
    ds_read_b128 v[172:175], v5 offset:13312
    ds_read_b128 v[180:183], v5 offset:4096
    ds_read_b128 v[184:187], v5 offset:9216
    ds_read_b128 v[188:191], v5 offset:14336
    s_waitcnt lgkmcnt(12)
    v_pk_add_f32 v[116:117], v[116:117], v[120:121]
    v_pk_add_f32 v[112:113], v[112:113], v[124:125]
    v_pk_add_f32 v[112:113], v[112:113], v[116:117]
    v_pk_add_f32 v[118:119], v[118:119], v[122:123]
    v_pk_add_f32 v[114:115], v[114:115], v[126:127]
    v_pk_add_f32 v[114:115], v[114:115], v[118:119]
    s_waitcnt lgkmcnt(9)
    v_pk_add_f32 v[132:133], v[132:133], v[136:137]
    v_pk_add_f32 v[128:129], v[128:129], v[140:141]
    v_pk_add_f32 v[128:129], v[128:129], v[132:133]
    v_pk_add_f32 v[134:135], v[134:135], v[138:139]
    v_pk_add_f32 v[130:131], v[130:131], v[142:143]
    v_pk_add_f32 v[130:131], v[130:131], v[134:135]
    s_waitcnt lgkmcnt(6)
    v_pk_add_f32 v[148:149], v[148:149], v[152:153]
    v_pk_add_f32 v[144:145], v[144:145], v[156:157]
    v_pk_add_f32 v[144:145], v[144:145], v[148:149]
    v_pk_add_f32 v[150:151], v[150:151], v[154:155]
    v_pk_add_f32 v[146:147], v[146:147], v[158:159]
    v_pk_add_f32 v[146:147], v[146:147], v[150:151]
    s_waitcnt lgkmcnt(3)
    v_pk_add_f32 v[164:165], v[164:165], v[168:169]
    v_pk_add_f32 v[160:161], v[160:161], v[172:173]
    v_pk_add_f32 v[160:161], v[160:161], v[164:165]
    v_pk_add_f32 v[166:167], v[166:167], v[170:171]
    v_pk_add_f32 v[162:163], v[162:163], v[174:175]
    v_pk_add_f32 v[162:163], v[162:163], v[166:167]
    s_waitcnt lgkmcnt(0)
    v_pk_add_f32 v[180:181], v[180:181], v[184:185]
    v_pk_add_f32 v[176:177], v[176:177], v[188:189]
    v_pk_add_f32 v[176:177], v[176:177], v[180:181]
    v_pk_add_f32 v[182:183], v[182:183], v[186:187]
    v_pk_add_f32 v[178:179], v[178:179], v[190:191]
    v_pk_add_f32 v[178:179], v[178:179], v[182:183]
    ds_read_b64_tr_b16 v[72:73], v192 offset:0
    ds_read_b64_tr_b16 v[74:75], v192 offset:512
    ds_read_b64_tr_b16 v[76:77], v192 offset:4096
    ds_read_b64_tr_b16 v[78:79], v192 offset:4608
    ds_read_b64_tr_b16 v[80:81], v193 offset:8192
    ds_read_b128 v[84:87], v194
    ds_read_b128 v[88:91], v194 offset:64
    ds_read_b64 v[92:93], v195 offset:128
    v_pk_mul_f32 v[52:53], v[112:113], s[50:51]
    v_pk_mul_f32 v[54:55], v[114:115], s[50:51]
    v_pk_mul_f32 v[56:57], v[128:129], s[50:51]
    v_pk_mul_f32 v[58:59], v[130:131], s[50:51]
    v_pk_mul_f32 v[60:61], v[144:145], s[50:51]
    v_pk_mul_f32 v[62:63], v[146:147], s[50:51]
    v_pk_mul_f32 v[64:65], v[160:161], s[50:51]
    v_pk_mul_f32 v[66:67], v[162:163], s[50:51]
    v_pk_mul_f32 v[68:69], v[176:177], s[50:51]
    v_pk_mul_f32 v[70:71], v[178:179], s[50:51]
    v_exp_f32 v52, v52
    v_exp_f32 v53, v53
    v_exp_f32 v54, v54
    v_exp_f32 v55, v55
    v_exp_f32 v56, v56
    v_exp_f32 v57, v57
    v_exp_f32 v58, v58
    v_exp_f32 v59, v59
    v_exp_f32 v60, v60
    v_exp_f32 v61, v61
    v_exp_f32 v62, v62
    v_exp_f32 v63, v63
    v_exp_f32 v64, v64
    v_exp_f32 v65, v65
    v_exp_f32 v66, v66
    v_exp_f32 v67, v67
    v_exp_f32 v68, v68
    v_exp_f32 v69, v69
    v_exp_f32 v70, v70
    v_exp_f32 v71, v71
    v_pk_add_f32 v[52:53], v[52:53], 1.0 op_sel_hi:[1,0]
    v_pk_add_f32 v[54:55], v[54:55], 1.0 op_sel_hi:[1,0]
    v_pk_add_f32 v[56:57], v[56:57], 1.0 op_sel_hi:[1,0]
    v_pk_add_f32 v[58:59], v[58:59], 1.0 op_sel_hi:[1,0]
    v_pk_add_f32 v[60:61], v[60:61], 1.0 op_sel_hi:[1,0]
    v_pk_add_f32 v[62:63], v[62:63], 1.0 op_sel_hi:[1,0]
    v_pk_add_f32 v[64:65], v[64:65], 1.0 op_sel_hi:[1,0]
    v_pk_add_f32 v[66:67], v[66:67], 1.0 op_sel_hi:[1,0]
    v_pk_add_f32 v[68:69], v[68:69], 1.0 op_sel_hi:[1,0]
    v_pk_add_f32 v[70:71], v[70:71], 1.0 op_sel_hi:[1,0]
    v_rcp_f32 v52, v52
    v_rcp_f32 v53, v53
    v_rcp_f32 v54, v54
    v_rcp_f32 v55, v55
    v_rcp_f32 v56, v56
    v_rcp_f32 v57, v57
    v_rcp_f32 v58, v58
    v_rcp_f32 v59, v59
    v_rcp_f32 v60, v60
    v_rcp_f32 v61, v61
    v_rcp_f32 v62, v62
    v_rcp_f32 v63, v63
    v_rcp_f32 v64, v64
    v_rcp_f32 v65, v65
    v_rcp_f32 v66, v66
    v_rcp_f32 v67, v67
    v_rcp_f32 v68, v68
    v_rcp_f32 v69, v69
    v_rcp_f32 v70, v70
    v_rcp_f32 v71, v71
    s_waitcnt lgkmcnt(0)
    v_pk_mul_f32 v[112:113], v[112:113], v[52:53]
    v_lshlrev_b32 v116, 16, v72
    v_and_b32 v117, 0xffff0000, v72
    v_lshlrev_b32 v120, 16, v84
    v_and_b32 v121, 0xffff0000, v84
    v_pk_fma_f32 v[112:113], v[112:113], v[116:117], v[120:121]
    v_cvt_pk_bf16_f32 v96, v112, v113
    v_pk_mul_f32 v[114:115], v[114:115], v[54:55]
    v_lshlrev_b32 v118, 16, v73
    v_and_b32 v119, 0xffff0000, v73
    v_lshlrev_b32 v122, 16, v85
    v_and_b32 v123, 0xffff0000, v85
    v_pk_fma_f32 v[114:115], v[114:115], v[118:119], v[122:123]
    v_cvt_pk_bf16_f32 v97, v114, v115
    v_pk_mul_f32 v[128:129], v[128:129], v[56:57]
    v_lshlrev_b32 v132, 16, v74
    v_and_b32 v133, 0xffff0000, v74
    v_lshlrev_b32 v136, 16, v86
    v_and_b32 v137, 0xffff0000, v86
    v_pk_fma_f32 v[128:129], v[128:129], v[132:133], v[136:137]
    v_cvt_pk_bf16_f32 v98, v128, v129
    v_pk_mul_f32 v[130:131], v[130:131], v[58:59]
    v_lshlrev_b32 v134, 16, v75
    v_and_b32 v135, 0xffff0000, v75
    v_lshlrev_b32 v138, 16, v87
    v_and_b32 v139, 0xffff0000, v87
    v_pk_fma_f32 v[130:131], v[130:131], v[134:135], v[138:139]
    v_cvt_pk_bf16_f32 v99, v130, v131
    ds_write_b128 v194, v[96:99]
    v_pk_mul_f32 v[144:145], v[144:145], v[60:61]
    v_lshlrev_b32 v148, 16, v76
    v_and_b32 v149, 0xffff0000, v76
    v_lshlrev_b32 v152, 16, v88
    v_and_b32 v153, 0xffff0000, v88
    v_pk_fma_f32 v[144:145], v[144:145], v[148:149], v[152:153]
    v_cvt_pk_bf16_f32 v100, v144, v145
    v_pk_mul_f32 v[146:147], v[146:147], v[62:63]
    v_lshlrev_b32 v150, 16, v77
    v_and_b32 v151, 0xffff0000, v77
    v_lshlrev_b32 v154, 16, v89
    v_and_b32 v155, 0xffff0000, v89
    v_pk_fma_f32 v[146:147], v[146:147], v[150:151], v[154:155]
    v_cvt_pk_bf16_f32 v101, v146, v147
    v_pk_mul_f32 v[160:161], v[160:161], v[64:65]
    v_lshlrev_b32 v164, 16, v78
    v_and_b32 v165, 0xffff0000, v78
    v_lshlrev_b32 v168, 16, v90
    v_and_b32 v169, 0xffff0000, v90
    v_pk_fma_f32 v[160:161], v[160:161], v[164:165], v[168:169]
    v_cvt_pk_bf16_f32 v102, v160, v161
    v_pk_mul_f32 v[162:163], v[162:163], v[66:67]
    v_lshlrev_b32 v166, 16, v79
    v_and_b32 v167, 0xffff0000, v79
    v_lshlrev_b32 v170, 16, v91
    v_and_b32 v171, 0xffff0000, v91
    v_pk_fma_f32 v[162:163], v[162:163], v[166:167], v[170:171]
    v_cvt_pk_bf16_f32 v103, v162, v163
    ds_write_b128 v194, v[100:103] offset:64
    v_pk_mul_f32 v[176:177], v[176:177], v[68:69]
    v_lshlrev_b32 v180, 16, v80
    v_and_b32 v181, 0xffff0000, v80
    v_lshlrev_b32 v184, 16, v92
    v_and_b32 v185, 0xffff0000, v92
    v_pk_fma_f32 v[176:177], v[176:177], v[180:181], v[184:185]
    v_cvt_pk_bf16_f32 v104, v176, v177
    v_pk_mul_f32 v[178:179], v[178:179], v[70:71]
    v_lshlrev_b32 v182, 16, v81
    v_and_b32 v183, 0xffff0000, v81
    v_lshlrev_b32 v186, 16, v93
    v_and_b32 v187, 0xffff0000, v93
    v_pk_fma_f32 v[178:179], v[178:179], v[182:183], v[186:187]
    v_cvt_pk_bf16_f32 v105, v178, v179
    ds_write_b64 v195, v[104:105] offset:128
    ds_read_b128 v[84:87], v245 offset:0
    ds_read_b128 v[88:91], v245 offset:1024
    ds_read_b128 v[92:95], v245 offset:2048
    s_waitcnt lgkmcnt(2)
    buffer_store_dwordx4 v[84:87], v246, s[32:35], s40 offen offset:0
    s_waitcnt lgkmcnt(1)
    buffer_store_dwordx4 v[88:91], v247, s[32:35], s40 offen offset:1024
    s_waitcnt lgkmcnt(0)
    s_mov_b32 exec_hi, 0
    buffer_store_dwordx4 v[92:95], v248, s[32:35], s40 offen offset:2048
    s_endpgm
S_role:
    s_load_dwordx2 s[4:5], s[0:1], 120
    s_load_dwordx2 s[8:9], s[0:1], 112
    v_lshrrev_b32 v2, 6, v0
    v_and_b32 v1, 63, v0
    v_readfirstlane_b32 s12, v2
    s_mov_b32 s6, 23068672
    s_mov_b32 s7, 0x20000
    s_mov_b32 s10, 256
    s_mov_b32 s11, 0x20000
    s_and_b32 s25, s2, 7
    s_lshr_b32 s24, s2, 3
    s_lshl_b32 s26, s25, 6
    s_lshl_b32 s15, s24, 1
    s_add_u32 s26, s26, s15
    s_add_u32 s27, s26, 1
    s_lshl_b32 s28, s25, 4
    s_add_u32 s28, s28, s24
    s_add_u32 s28, s28, 512
    s_cmp_lt_u32 s24, 16
    s_cselect_b32 s57, 1, 0
    v_mov_b32 v6, 0
    v_lshlrev_b32 v8, 4, v1
    s_setprio 1
    s_lshr_b32 s31, s12, 1
    s_cmp_eq_u32 s12, 3
    s_cbranch_scc1 S_ln
    s_add_u32 s15, s57, 2
    s_cmp_ge_u32 s12, s15
    s_cbranch_scc1 S_w2t
    s_load_dwordx2 s[32:33], s[0:1], 8
    s_load_dwordx2 s[36:37], s[0:1], 16
    s_load_dwordx2 s[40:41], s[0:1], 24
    s_load_dwordx2 s[44:45], s[0:1], 32
    s_load_dwordx2 s[48:49], s[0:1], 40
    s_load_dwordx2 s[52:53], s[0:1], 48
    s_load_dwordx2 s[20:21], s[0:1], 56
    s_load_dwordx2 s[18:19], s[0:1], 64
    s_cmp_eq_u32 s12, 1
    s_cselect_b32 s58, s27, s26
    s_cmp_eq_u32 s12, 2
    s_cselect_b32 s58, s28, s58
    s_mov_b32 s34, 245760
    s_mov_b32 s35, 0x20000
    s_mov_b32 s38, 245760
    s_mov_b32 s39, 0x20000
    s_mov_b32 s42, 245760
    s_mov_b32 s43, 0x20000
    s_mov_b32 s46, 245760
    s_mov_b32 s47, 0x20000
    s_mov_b32 s50, 245760
    s_mov_b32 s51, 0x20000
    s_mov_b32 s54, 245760
    s_mov_b32 s55, 0x20000
    s_mov_b32 s22, 1280
    s_mov_b32 s23, 0x20000
    s_mul_i32 s15, s58, 384
    v_lshlrev_b32 v32, 1, v1
    s_lshl_b32 s16, s58, 1
    s_waitcnt lgkmcnt(0)
    buffer_load_ushort v29, v6, s[20:23], s16 offen
    s_mov_b32 s20, s18
    s_mov_b32 s21, s19
    buffer_load_ushort v9, v6, s[20:23], s16 offen
    buffer_load_ushort v11, v32, s[32:35], s15 offen offset:0
    buffer_load_ushort v12, v32, s[36:39], s15 offen offset:0
    buffer_load_ushort v13, v32, s[40:43], s15 offen offset:0
    buffer_load_ushort v14, v32, s[44:47], s15 offen offset:0
    buffer_load_ushort v15, v32, s[48:51], s15 offen offset:0
    buffer_load_ushort v16, v32, s[52:55], s15 offen offset:0
    buffer_load_ushort v17, v32, s[32:35], s15 offen offset:128
    buffer_load_ushort v18, v32, s[36:39], s15 offen offset:128
    buffer_load_ushort v19, v32, s[40:43], s15 offen offset:128
    buffer_load_ushort v20, v32, s[44:47], s15 offen offset:128
    buffer_load_ushort v21, v32, s[48:51], s15 offen offset:128
    buffer_load_ushort v22, v32, s[52:55], s15 offen offset:128
    buffer_load_ushort v23, v32, s[32:35], s15 offen offset:256
    buffer_load_ushort v24, v32, s[36:39], s15 offen offset:256
    buffer_load_ushort v25, v32, s[40:43], s15 offen offset:256
    buffer_load_ushort v26, v32, s[44:47], s15 offen offset:256
    buffer_load_ushort v27, v32, s[48:51], s15 offen offset:256
    buffer_load_ushort v28, v32, s[52:55], s15 offen offset:256
    s_mul_i32 s59, s12, 17408
    v_mul_u32_u24 v30, 272, v1
    v_add_u32 v30, s59, v30
    v_bfe_u32 v2, v1, 2, 2
    v_lshrrev_b32 v3, 5, v1
    v_lshl_add_u32 v2, v2, 2, v3
    v_mul_u32_u24 v2, 272, v2
    v_bfe_u32 v3, v1, 4, 1
    v_lshl_add_u32 v2, v3, 5, v2
    v_and_b32 v3, 3, v1
    v_lshl_add_u32 v2, v3, 3, v2
    v_add_u32 v31, s59, v2
    v_mov_b32 v173, 0
    v_mov_b32 v189, 0
    v_mov_b32 v175, 0
    v_mov_b32 v191, 0
    s_waitcnt vmcnt(0)
    v_lshlrev_b32 v29, 16, v29
    v_mul_f32 v2, 0x3fb8aa3b, v29
    s_mov_b32 s15, 0x3fb8aa3b
    v_fma_f32 v3, v29, s15, -v2
    v_fmac_f32 v3, 0x32a57060, v29
    v_exp_f32 v2, v2
    v_mul_f32 v3, 0x3f317218, v3
    v_fma_f32 v2, v2, v3, v2
    v_cvt_pk_bf16_f32 v29, v2, v2
    v_and_b32 v29, 0xffff0000, v29
    s_mov_b32 s29, 0
KG_loop:
    v_lshlrev_b32 v11, 16, v11
    v_lshlrev_b32 v12, 16, v12
    v_lshlrev_b32 v13, 16, v13
    v_lshlrev_b32 v14, 16, v14
    v_lshlrev_b32 v140, 16, v15
    v_lshlrev_b32 v141, 16, v16
    v_mul_f32 v11, v29, v11
    v_mul_f32 v12, v29, v12
    v_mul_f32 v132, v29, v13
    v_mul_f32 v133, v29, v14
    v_mul_f32 v142, 0x3fb8aa3b, v11
    v_mul_f32 v143, 0x3e22f983, v12
    v_mul_f32 v122, v140, v132
    v_mul_f32 v123, v140, v133
    v_fma_f32 v122, -v141, v133, v122
    v_fmac_f32 v123, v141, v132
    v_mul_f32 v2, 0x41000000, v142
    v_mul_f32 v3, 0x41000000, v143
    v_exp_f32 v2, v2
    v_fract_f32 v3, v3
    v_cos_f32 v118, v3
    v_sin_f32 v119, v3
    v_mul_f32 v118, v118, v2
    v_mul_f32 v119, v119, v2
    v_exp_f32 v2, v142
    v_fract_f32 v3, v143
    v_cos_f32 v116, v3
    v_sin_f32 v117, v3
    v_mul_f32 v116, v116, v2
    v_mul_f32 v117, v117, v2
    v_mul_f32 v2, 0x43800000, v142
    v_mul_f32 v3, 0x43800000, v143
    v_exp_f32 v2, v2
    v_fract_f32 v3, v3
    v_cos_f32 v120, v3
    v_sin_f32 v121, v3
    v_mul_f32 v120, v120, v2
    v_mul_f32 v121, v121, v2
    s_waitcnt lgkmcnt(0)
    v_cvt_pk_bf16_f32 v144, 1.0, v118
    v_cvt_pk_bf16_f32 v152, 0, v119
    v_mfma_f32_32x32x16_bf16 v[36:51], v[52:55], v[84:87], v[36:51]
    v_mul_f32 v124, v118, v118
    v_mul_f32 v125, v118, v119
    v_fma_f32 v124, -v119, v119, v124
    v_fmac_f32 v125, v119, v118
    v_mul_f32 v126, v124, v118
    v_mul_f32 v127, v124, v119
    v_fma_f32 v126, -v125, v119, v126
    v_fmac_f32 v127, v125, v118
    v_cvt_pk_bf16_f32 v145, v124, v126
    v_cvt_pk_bf16_f32 v153, v125, v127
    v_mfma_f32_32x32x16_bf16 v[36:51], v[56:59], v[88:91], v[36:51]
    v_mul_f32 v124, v126, v118
    v_mul_f32 v125, v126, v119
    v_fma_f32 v124, -v127, v119, v124
    v_fmac_f32 v125, v127, v118
    v_mul_f32 v126, v124, v118
    v_mul_f32 v127, v124, v119
    v_fma_f32 v126, -v125, v119, v126
    v_fmac_f32 v127, v125, v118
    v_cvt_pk_bf16_f32 v146, v124, v126
    v_cvt_pk_bf16_f32 v154, v125, v127
    v_mfma_f32_32x32x16_bf16 v[36:51], v[60:63], v[92:95], v[36:51]
    v_mul_f32 v124, v126, v118
    v_mul_f32 v125, v126, v119
    v_fma_f32 v124, -v127, v119, v124
    v_fmac_f32 v125, v127, v118
    v_mul_f32 v126, v124, v118
    v_mul_f32 v127, v124, v119
    v_fma_f32 v126, -v125, v119, v126
    v_fmac_f32 v127, v125, v118
    v_cvt_pk_bf16_f32 v147, v124, v126
    v_cvt_pk_bf16_f32 v155, v125, v127
    ds_write_b128 v30, v[144:147] offset:0
    ds_write_b128 v30, v[152:155] offset:64
    v_mfma_f32_32x32x16_bf16 v[36:51], v[64:67], v[96:99], v[36:51]
    v_mul_f32 v124, v126, v118
    v_mul_f32 v125, v126, v119
    v_fma_f32 v124, -v127, v119, v124
    v_fmac_f32 v125, v127, v118
    v_mul_f32 v126, v124, v118
    v_mul_f32 v127, v124, v119
    v_fma_f32 v126, -v125, v119, v126
    v_fmac_f32 v127, v125, v118
    v_cvt_pk_bf16_f32 v148, v124, v126
    v_cvt_pk_bf16_f32 v156, v125, v127
    v_mfma_f32_32x32x16_bf16 v[36:51], v[68:71], v[100:103], v[36:51]
    v_mul_f32 v124, v126, v118
    v_mul_f32 v125, v126, v119
    v_fma_f32 v124, -v127, v119, v124
    v_fmac_f32 v125, v127, v118
    v_mul_f32 v126, v124, v118
    v_mul_f32 v127, v124, v119
    v_fma_f32 v126, -v125, v119, v126
    v_fmac_f32 v127, v125, v118
    v_cvt_pk_bf16_f32 v149, v124, v126
    v_cvt_pk_bf16_f32 v157, v125, v127
    v_mfma_f32_32x32x16_bf16 v[36:51], v[72:75], v[104:107], v[36:51]
    v_mul_f32 v124, v126, v118
    v_mul_f32 v125, v126, v119
    v_fma_f32 v124, -v127, v119, v124
    v_fmac_f32 v125, v127, v118
    v_mul_f32 v126, v124, v118
    v_mul_f32 v127, v124, v119
    v_fma_f32 v126, -v125, v119, v126
    v_fmac_f32 v127, v125, v118
    v_cvt_pk_bf16_f32 v150, v124, v126
    v_cvt_pk_bf16_f32 v158, v125, v127
    v_mfma_f32_32x32x16_bf16 v[36:51], v[76:79], v[108:111], v[36:51]
    v_mul_f32 v124, v126, v118
    v_mul_f32 v125, v126, v119
    v_fma_f32 v124, -v127, v119, v124
    v_fmac_f32 v125, v127, v118
    v_mul_f32 v126, v124, v118
    v_mul_f32 v127, v124, v119
    v_fma_f32 v126, -v125, v119, v126
    v_fmac_f32 v127, v125, v118
    v_cvt_pk_bf16_f32 v151, v124, v126
    v_cvt_pk_bf16_f32 v159, v125, v127
    ds_write_b128 v30, v[148:151] offset:16
    ds_write_b128 v30, v[156:159] offset:80
    v_mfma_f32_32x32x16_bf16 v[36:51], v[80:83], v[112:115], v[36:51]
    v_mul_f32 v124, v126, v118
    v_mul_f32 v125, v126, v119
    v_fma_f32 v124, -v127, v119, v124
    v_fmac_f32 v125, v127, v118
    v_mul_f32 v126, v124, v118
    v_mul_f32 v127, v124, v119
    v_fma_f32 v126, -v125, v119, v126
    v_fmac_f32 v127, v125, v118
    v_cvt_pk_bf16_f32 v144, v124, v126
    v_cvt_pk_bf16_f32 v152, v125, v127
    v_mul_f32 v124, v126, v118
    v_mul_f32 v125, v126, v119
    v_fma_f32 v124, -v127, v119, v124
    v_fmac_f32 v125, v127, v118
    v_mul_f32 v126, v124, v118
    v_mul_f32 v127, v124, v119
    v_fma_f32 v126, -v125, v119, v126
    v_fmac_f32 v127, v125, v118
    v_cvt_pk_bf16_f32 v145, v124, v126
    v_cvt_pk_bf16_f32 v153, v125, v127
    v_mul_f32 v124, v126, v118
    v_mul_f32 v125, v126, v119
    v_fma_f32 v124, -v127, v119, v124
    v_fmac_f32 v125, v127, v118
    v_mul_f32 v126, v124, v118
    v_mul_f32 v127, v124, v119
    v_fma_f32 v126, -v125, v119, v126
    v_fmac_f32 v127, v125, v118
    v_cvt_pk_bf16_f32 v146, v124, v126
    v_cvt_pk_bf16_f32 v154, v125, v127
    v_mul_f32 v124, v126, v118
    v_mul_f32 v125, v126, v119
    v_fma_f32 v124, -v127, v119, v124
    v_fmac_f32 v125, v127, v118
    v_mul_f32 v126, v124, v118
    v_mul_f32 v127, v124, v119
    v_fma_f32 v126, -v125, v119, v126
    v_fmac_f32 v127, v125, v118
    v_cvt_pk_bf16_f32 v147, v124, v126
    v_cvt_pk_bf16_f32 v155, v125, v127
    ds_write_b128 v30, v[144:147] offset:32
    ds_write_b128 v30, v[152:155] offset:96
    v_mul_f32 v124, v126, v118
    v_mul_f32 v125, v126, v119
    v_fma_f32 v124, -v127, v119, v124
    v_fmac_f32 v125, v127, v118
    v_mul_f32 v126, v124, v118
    v_mul_f32 v127, v124, v119
    v_fma_f32 v126, -v125, v119, v126
    v_fmac_f32 v127, v125, v118
    v_cvt_pk_bf16_f32 v148, v124, v126
    v_cvt_pk_bf16_f32 v156, v125, v127
    v_mul_f32 v124, v126, v118
    v_mul_f32 v125, v126, v119
    v_fma_f32 v124, -v127, v119, v124
    v_fmac_f32 v125, v127, v118
    v_mul_f32 v126, v124, v118
    v_mul_f32 v127, v124, v119
    v_fma_f32 v126, -v125, v119, v126
    v_fmac_f32 v127, v125, v118
    v_cvt_pk_bf16_f32 v149, v124, v126
    v_cvt_pk_bf16_f32 v157, v125, v127
    v_mul_f32 v124, v126, v118
    v_mul_f32 v125, v126, v119
    v_fma_f32 v124, -v127, v119, v124
    v_fmac_f32 v125, v127, v118
    v_mul_f32 v126, v124, v118
    v_mul_f32 v127, v124, v119
    v_fma_f32 v126, -v125, v119, v126
    v_fmac_f32 v127, v125, v118
    v_cvt_pk_bf16_f32 v150, v124, v126
    v_cvt_pk_bf16_f32 v158, v125, v127
    v_mul_f32 v124, v126, v118
    v_mul_f32 v125, v126, v119
    v_fma_f32 v124, -v127, v119, v124
    v_fmac_f32 v125, v127, v118
    v_mul_f32 v126, v124, v118
    v_mul_f32 v127, v124, v119
    v_fma_f32 v126, -v125, v119, v126
    v_fmac_f32 v127, v125, v118
    v_cvt_pk_bf16_f32 v151, v124, v126
    v_cvt_pk_bf16_f32 v159, v125, v127
    ds_write_b128 v30, v[148:151] offset:48
    ds_write_b128 v30, v[156:159] offset:112
    v_mul_f32 v124, v122, v116
    v_mul_f32 v125, v122, v117
    v_fma_f32 v124, -v123, v117, v124
    v_fmac_f32 v125, v123, v116
    v_cvt_pk_bf16_f32 v160, v122, v124
    v_cvt_pk_bf16_f32 v176, -v123, -v125
    v_mul_f32 v134, v124, v116
    v_mul_f32 v135, v124, v117
    v_fma_f32 v134, -v125, v117, v134
    v_fmac_f32 v135, v125, v116
    v_mul_f32 v124, v134, v116
    v_mul_f32 v125, v134, v117
    v_fma_f32 v124, -v135, v117, v124
    v_fmac_f32 v125, v135, v116
    v_cvt_pk_bf16_f32 v161, v134, v124
    v_cvt_pk_bf16_f32 v177, -v135, -v125
    v_mul_f32 v136, v124, v116
    v_mul_f32 v137, v124, v117
    v_fma_f32 v136, -v125, v117, v136
    v_fmac_f32 v137, v125, v116
    v_mul_f32 v124, v136, v116
    v_mul_f32 v125, v136, v117
    v_fma_f32 v124, -v137, v117, v124
    v_fmac_f32 v125, v137, v116
    v_cvt_pk_bf16_f32 v164, v136, v124
    v_cvt_pk_bf16_f32 v180, -v137, -v125
    v_mul_f32 v138, v124, v116
    v_mul_f32 v139, v124, v117
    v_fma_f32 v138, -v125, v117, v138
    v_fmac_f32 v139, v125, v116
    v_mul_f32 v124, v138, v116
    v_mul_f32 v125, v138, v117
    v_fma_f32 v124, -v139, v117, v124
    v_fmac_f32 v125, v139, v116
    v_cvt_pk_bf16_f32 v165, v138, v124
    v_cvt_pk_bf16_f32 v181, -v139, -v125
    v_mul_f32 v124, v134, v120
    v_mul_f32 v125, v134, v121
    v_fma_f32 v124, -v135, v121, v124
    v_fmac_f32 v125, v135, v120
    v_mul_f32 v126, v138, v120
    v_mul_f32 v127, v138, v121
    v_fma_f32 v126, -v139, v121, v126
    v_fmac_f32 v127, v139, v120
    v_cvt_pk_bf16_f32 v163, v124, v126
    v_cvt_pk_bf16_f32 v179, -v125, -v127
    v_mul_f32 v124, v136, v120
    v_mul_f32 v125, v136, v121
    v_fma_f32 v124, -v137, v121, v124
    v_fmac_f32 v125, v137, v120
    v_mul_f32 v126, v124, v120
    v_mul_f32 v127, v124, v121
    v_fma_f32 v126, -v125, v121, v126
    v_fmac_f32 v127, v125, v120
    v_cvt_pk_bf16_f32 v167, v124, v126
    v_cvt_pk_bf16_f32 v183, -v125, -v127
    v_mul_f32 v124, v126, v120
    v_mul_f32 v125, v126, v121
    v_fma_f32 v124, -v127, v121, v124
    v_fmac_f32 v125, v127, v120
    v_cvt_pk_bf16_f32 v171, v124, v124
    v_cvt_pk_bf16_f32 v187, -v125, -v125
    v_mul_f32 v128, v122, v120
    v_mul_f32 v129, v122, v121
    v_fma_f32 v128, -v123, v121, v128
    v_fmac_f32 v129, v123, v120
    v_mul_f32 v126, v128, v118
    v_mul_f32 v127, v128, v119
    v_fma_f32 v126, -v129, v119, v126
    v_fmac_f32 v127, v129, v118
    v_cvt_pk_bf16_f32 v162, v128, v126
    v_cvt_pk_bf16_f32 v178, -v129, -v127
    ds_write_b128 v30, v[160:163] offset:128
    ds_write_b128 v30, v[176:179] offset:192
    v_mul_f32 v124, v128, v120
    v_mul_f32 v125, v128, v121
    v_fma_f32 v124, -v129, v121, v124
    v_fmac_f32 v125, v129, v120
    v_mul_f32 v126, v124, v118
    v_mul_f32 v127, v124, v119
    v_fma_f32 v126, -v125, v119, v126
    v_fmac_f32 v127, v125, v118
    v_cvt_pk_bf16_f32 v166, v124, v126
    v_cvt_pk_bf16_f32 v182, -v125, -v127
    ds_write_b128 v30, v[164:167] offset:144
    ds_write_b128 v30, v[180:183] offset:208
    v_mul_f32 v128, v124, v120
    v_mul_f32 v129, v124, v121
    v_fma_f32 v128, -v125, v121, v128
    v_fmac_f32 v129, v125, v120
    v_mul_f32 v126, v128, v118
    v_mul_f32 v127, v128, v119
    v_fma_f32 v126, -v129, v119, v126
    v_fmac_f32 v127, v129, v118
    v_cvt_pk_bf16_f32 v170, v128, v126
    v_cvt_pk_bf16_f32 v186, -v129, -v127
    v_mul_f32 v124, v128, v120
    v_mul_f32 v125, v128, v121
    v_fma_f32 v124, -v129, v121, v124
    v_fmac_f32 v125, v129, v120
    v_mul_f32 v126, v124, v118
    v_mul_f32 v127, v124, v119
    v_fma_f32 v126, -v125, v119, v126
    v_fmac_f32 v127, v125, v118
    v_cvt_pk_bf16_f32 v168, v124, v126
    v_cvt_pk_bf16_f32 v184, -v125, -v127
    v_mul_f32 v128, v124, v120
    v_mul_f32 v129, v124, v121
    v_fma_f32 v128, -v125, v121, v128
    v_fmac_f32 v129, v125, v120
    v_mul_f32 v126, v128, v118
    v_mul_f32 v127, v128, v119
    v_fma_f32 v126, -v129, v119, v126
    v_fmac_f32 v127, v129, v118
    v_cvt_pk_bf16_f32 v169, v128, v126
    v_cvt_pk_bf16_f32 v185, -v129, -v127
    ds_write_b128 v30, v[168:171] offset:160
    ds_write_b128 v30, v[184:187] offset:224
    v_mul_f32 v124, v128, v120
    v_mul_f32 v125, v128, v121
    v_fma_f32 v124, -v129, v121, v124
    v_fmac_f32 v125, v129, v120
    v_mul_f32 v126, v124, v118
    v_mul_f32 v127, v124, v119
    v_fma_f32 v126, -v125, v119, v126
    v_fmac_f32 v127, v125, v118
    v_cvt_pk_bf16_f32 v172, v124, v126
    v_cvt_pk_bf16_f32 v188, -v125, -v127
    v_mul_f32 v128, v124, v120
    v_mul_f32 v129, v124, v121
    v_fma_f32 v128, -v125, v121, v128
    v_fmac_f32 v129, v125, v120
    v_mul_f32 v126, v128, v118
    v_mul_f32 v127, v128, v119
    v_fma_f32 v126, -v129, v119, v126
    v_fmac_f32 v127, v129, v118
    v_cvt_pk_bf16_f32 v174, v128, v126
    v_cvt_pk_bf16_f32 v190, -v129, -v127
    ds_write_b128 v30, v[172:175] offset:176
    ds_write_b128 v30, v[188:191] offset:240
    ds_read_b64_tr_b16 v[52:53], v31 offset:128
    ds_read_b64_tr_b16 v[54:55], v31 offset:192
    ds_read_b64_tr_b16 v[84:85], v31 offset:0
    ds_read_b64_tr_b16 v[86:87], v31 offset:64
    ds_read_b64_tr_b16 v[56:57], v31 offset:672
    ds_read_b64_tr_b16 v[58:59], v31 offset:736
    ds_read_b64_tr_b16 v[88:89], v31 offset:544
    ds_read_b64_tr_b16 v[90:91], v31 offset:608
    ds_read_b64_tr_b16 v[60:61], v31 offset:4480
    ds_read_b64_tr_b16 v[62:63], v31 offset:4544
    ds_read_b64_tr_b16 v[92:93], v31 offset:4352
    ds_read_b64_tr_b16 v[94:95], v31 offset:4416
    ds_read_b64_tr_b16 v[64:65], v31 offset:5024
    ds_read_b64_tr_b16 v[66:67], v31 offset:5088
    ds_read_b64_tr_b16 v[96:97], v31 offset:4896
    ds_read_b64_tr_b16 v[98:99], v31 offset:4960
    ds_read_b64_tr_b16 v[68:69], v31 offset:8832
    ds_read_b64_tr_b16 v[70:71], v31 offset:8896
    ds_read_b64_tr_b16 v[100:101], v31 offset:8704
    ds_read_b64_tr_b16 v[102:103], v31 offset:8768
    ds_read_b64_tr_b16 v[72:73], v31 offset:9376
    ds_read_b64_tr_b16 v[74:75], v31 offset:9440
    ds_read_b64_tr_b16 v[104:105], v31 offset:9248
    ds_read_b64_tr_b16 v[106:107], v31 offset:9312
    ds_read_b64_tr_b16 v[76:77], v31 offset:13184
    ds_read_b64_tr_b16 v[78:79], v31 offset:13248
    ds_read_b64_tr_b16 v[108:109], v31 offset:13056
    ds_read_b64_tr_b16 v[110:111], v31 offset:13120
    ds_read_b64_tr_b16 v[80:81], v31 offset:13728
    ds_read_b64_tr_b16 v[82:83], v31 offset:13792
    ds_read_b64_tr_b16 v[112:113], v31 offset:13600
    ds_read_b64_tr_b16 v[114:115], v31 offset:13664
    v_mov_b32 v11, v17
    v_mov_b32 v17, v23
    v_mov_b32 v12, v18
    v_mov_b32 v18, v24
    v_mov_b32 v13, v19
    v_mov_b32 v19, v25
    v_mov_b32 v14, v20
    v_mov_b32 v20, v26
    v_mov_b32 v15, v21
    v_mov_b32 v21, v27
    v_mov_b32 v16, v22
    v_mov_b32 v22, v28
    s_cmp_eq_u32 s29, 0
    s_cselect_b32 s15, 0, -1
    v_and_b32 v36, s15, v36
    v_and_b32 v37, s15, v37
    v_and_b32 v38, s15, v38
    v_and_b32 v39, s15, v39
    v_and_b32 v40, s15, v40
    v_and_b32 v41, s15, v41
    v_and_b32 v42, s15, v42
    v_and_b32 v43, s15, v43
    v_and_b32 v44, s15, v44
    v_and_b32 v45, s15, v45
    v_and_b32 v46, s15, v46
    v_and_b32 v47, s15, v47
    v_and_b32 v48, s15, v48
    v_and_b32 v49, s15, v49
    v_and_b32 v50, s15, v50
    v_and_b32 v51, s15, v51
    s_add_u32 s29, s29, 1
    s_cmp_lt_u32 s29, 3
    s_cbranch_scc1 KG_loop
KG_after:
    buffer_load_dword v7, v6, s[8:11], 0 offen sc1
    v_and_b32 v2, 31, v1
    v_lshlrev_b32 v2, 4, v2
    v_lshrrev_b32 v3, 5, v1
    v_lshl_add_u32 v4, v3, 9, v2
    s_add_u32 s15, s59, 1008
    v_sub_u32 v11, s15, v4
    v_lshlrev_b32 v4, 10, v3
    v_sub_u32 v4, v4, v2
    s_add_u32 s15, s59, 496
    v_add_u32 v12, s15, v4
    v_mov_b32 v144, 0
    v_mov_b32 v145, 0
    v_mov_b32 v146, 0
    v_mov_b32 v147, 0
    v_lshrrev_b32 v13, 2, v1
    v_mul_u32_u24 v13, 4160, v13
    v_and_b32 v14, 3, v1
    v_lshl_add_u32 v13, v14, 4, v13
    v_add_u32 v13, s59, v13
    s_mov_b32 s18, 0xaaaaaaaa
    s_mov_b32 s19, 0xaaaaaaaa
    s_waitcnt lgkmcnt(0)
    v_mfma_f32_32x32x16_bf16 v[36:51], v[52:55], v[84:87], v[36:51]
    v_mfma_f32_32x32x16_bf16 v[36:51], v[56:59], v[88:91], v[36:51]
    v_mfma_f32_32x32x16_bf16 v[36:51], v[60:63], v[92:95], v[36:51]
    v_mfma_f32_32x32x16_bf16 v[36:51], v[64:67], v[96:99], v[36:51]
    v_mfma_f32_32x32x16_bf16 v[36:51], v[68:71], v[100:103], v[36:51]
    v_mfma_f32_32x32x16_bf16 v[36:51], v[72:75], v[104:107], v[36:51]
    v_mfma_f32_32x32x16_bf16 v[36:51], v[76:79], v[108:111], v[36:51]
    v_mfma_f32_32x32x16_bf16 v[36:51], v[80:83], v[112:115], v[36:51]
    s_mov_b64 exec, 0xffff
    ds_write_b128 v13, v[144:147] offset:4096
    s_mov_b64 exec, -1
    s_nop 8
    v_cndmask_b32 v2, v48, v49, s[18:19]
    v_cvt_pk_bf16_f32 v184, v49, v49
    v_cvt_pk_bf16_f32 v185, v49, v2
    v_cvt_pk_bf16_f32 v186, v48, v48
    v_cvt_pk_bf16_f32 v187, v48, v48
    v_lshlrev_b32 v9, 16, v9
    s_mov_b64 exec, 1
    v_add_f32 v36, v36, v9
    s_mov_b32 exec_lo, -1
    v_cvt_pk_bf16_f32 v160, v43, v42
    v_cvt_pk_bf16_f32 v161, v41, v40
    v_cvt_pk_bf16_f32 v162, v39, v38
    v_cvt_pk_bf16_f32 v163, v37, v36
    v_cndmask_b32 v2, v44, v45, s[18:19]
    v_cvt_pk_bf16_f32 v168, v45, v45
    v_cvt_pk_bf16_f32 v169, v45, v2
    v_cvt_pk_bf16_f32 v170, v44, v44
    v_cvt_pk_bf16_f32 v171, v44, v44
    v_cndmask_b32 v2, v46, v47, s[18:19]
    v_cvt_pk_bf16_f32 v176, v47, v47
    v_cvt_pk_bf16_f32 v177, v47, v2
    v_cvt_pk_bf16_f32 v178, v46, v46
    v_cvt_pk_bf16_f32 v179, v46, v46
    s_mov_b32 exec_hi, -1
    s_mov_b32 exec_lo, 0
    v_cvt_pk_bf16_f32 v160, v37, v39
    v_cvt_pk_bf16_f32 v161, v42, v42
    v_cvt_pk_bf16_f32 v162, v42, v38
    v_cvt_pk_bf16_f32 v163, v36, v36
    v_cvt_pk_bf16_f32 v168, v41, v41
    v_cvt_pk_bf16_f32 v169, v43, v43
    v_cvt_pk_bf16_f32 v170, v43, v40
    v_cvt_pk_bf16_f32 v171, v40, v40
    v_cvt_pk_bf16_f32 v176, v45, v45
    v_cvt_pk_bf16_f32 v177, v46, v46
    v_cvt_pk_bf16_f32 v178, v46, v44
    v_cvt_pk_bf16_f32 v179, v44, v44
    s_mov_b32 exec_lo, -1
    ds_write_b128 v11, v[160:163] offset:3072
    ds_write_b128 v12, v[168:171] offset:1536
    ds_write_b128 v12, v[176:179] offset:1024
    ds_write_b128 v11, v[184:187] offset:0
    ds_read_b64 v[164:165], v11 offset:3088
    ds_read_b64 v[172:173], v12 offset:1552
    ds_read_b64 v[180:181], v12 offset:1040
    ds_read_b64 v[188:189], v11 offset:16
    s_waitcnt vmcnt(0)
    v_readfirstlane_b32 s13, v7
    s_nop 0
    s_cmp_lg_u32 s13, 0
    s_cbranch_scc1 TK_9
    s_mov_b32 s14, 0
TL_10:
    s_sleep 2
    buffer_load_dword v7, v6, s[8:11], 0 offen sc1
    s_waitcnt vmcnt(0)
    v_readfirstlane_b32 s13, v7
    s_nop 0
    s_cmp_lg_u32 s13, 0
    s_cbranch_scc1 TK_9
    s_add_u32 s14, s14, 1
    s_cmp_lt_u32 s14, 16384
    s_cbranch_scc1 TL_10
TK_9:
    s_waitcnt lgkmcnt(0)
    v_alignbyte_b32 v52, v161, v160, 2
    v_alignbyte_b32 v53, v162, v161, 2
    v_alignbyte_b32 v54, v163, v162, 2
    v_alignbyte_b32 v55, v164, v163, 2
    v_mov_b32 v56, v161
    v_mov_b32 v57, v162
    v_mov_b32 v58, v163
    v_mov_b32 v59, v164
    v_alignbyte_b32 v60, v162, v161, 2
    v_alignbyte_b32 v61, v163, v162, 2
    v_alignbyte_b32 v62, v164, v163, 2
    v_alignbyte_b32 v63, v165, v164, 2
    ds_write_b128 v11, v[52:55] offset:7232
    ds_write_b128 v11, v[56:59] offset:11392
    ds_write_b128 v11, v[60:63] offset:15552
    v_alignbyte_b32 v64, v169, v168, 2
    v_alignbyte_b32 v65, v170, v169, 2
    v_alignbyte_b32 v66, v171, v170, 2
    v_alignbyte_b32 v67, v172, v171, 2
    v_mov_b32 v68, v169
    v_mov_b32 v69, v170
    v_mov_b32 v70, v171
    v_mov_b32 v71, v172
    v_alignbyte_b32 v72, v170, v169, 2
    v_alignbyte_b32 v73, v171, v170, 2
    v_alignbyte_b32 v74, v172, v171, 2
    v_alignbyte_b32 v75, v173, v172, 2
    ds_write_b128 v12, v[64:67] offset:5696
    ds_write_b128 v12, v[68:71] offset:9856
    ds_write_b128 v12, v[72:75] offset:14016
    v_alignbyte_b32 v76, v177, v176, 2
    v_alignbyte_b32 v77, v178, v177, 2
    v_alignbyte_b32 v78, v179, v178, 2
    v_alignbyte_b32 v79, v180, v179, 2
    v_mov_b32 v80, v177
    v_mov_b32 v81, v178
    v_mov_b32 v82, v179
    v_mov_b32 v83, v180
    v_alignbyte_b32 v52, v178, v177, 2
    v_alignbyte_b32 v53, v179, v178, 2
    v_alignbyte_b32 v54, v180, v179, 2
    v_alignbyte_b32 v55, v181, v180, 2
    ds_write_b128 v12, v[76:79] offset:5184
    ds_write_b128 v12, v[80:83] offset:9344
    ds_write_b128 v12, v[52:55] offset:13504
    v_alignbyte_b32 v56, v185, v184, 2
    v_alignbyte_b32 v57, v186, v185, 2
    v_alignbyte_b32 v58, v187, v186, 2
    v_alignbyte_b32 v59, v188, v187, 2
    v_mov_b32 v60, v185
    v_mov_b32 v61, v186
    v_mov_b32 v62, v187
    v_mov_b32 v63, v188
    v_alignbyte_b32 v64, v186, v185, 2
    v_alignbyte_b32 v65, v187, v186, 2
    v_alignbyte_b32 v66, v188, v187, 2
    v_alignbyte_b32 v67, v189, v188, 2
    ds_write_b128 v11, v[56:59] offset:4160
    ds_write_b128 v11, v[60:63] offset:8320
    ds_write_b128 v11, v[64:67] offset:12480
    s_branch S_join
S_w2t:
    s_waitcnt lgkmcnt(0)
    v_mov_b32 v7, 0
    s_nop 0
    v_readfirstlane_b32 s13, v7
    s_nop 0
    s_cmp_lg_u32 s13, 0
    s_cbranch_scc1 TK_11
    s_mov_b32 s14, 0
TL_12:
    s_sleep 32
    buffer_load_dword v7, v6, s[8:11], 0 offen sc1
    s_waitcnt vmcnt(0)
    v_readfirstlane_b32 s13, v7
    s_nop 0
    s_cmp_lg_u32 s13, 0
    s_cbranch_scc1 TK_11
    s_add_u32 s14, s14, 1
    s_cmp_lt_u32 s14, 16384
    s_cbranch_scc1 TL_12
TK_11:
    s_branch S_join
S_ln:
    s_load_dwordx2 s[20:21], s[0:1], 0
    s_memrealtime s[18:19]
    s_mov_b32 s22, 2621440
    s_mov_b32 s23, 0x20000
    v_lshrrev_b32 v2, 3, v1
    v_and_b32 v3, 7, v1
    v_lshlrev_b32 v3, 4, v3
    v_mul_u32_u24 v11, 1280, v2
    v_add_u32 v11, v11, v3
    v_mul_u32_u24 v12, 1344, v2
    v_add_u32 v12, v12, v3
    v_add_u32 v12, 66048, v12
    s_lshl_b32 s17, s25, 5
    s_add_u32 s17, s17, s24
    s_mul_i32 s15, s17, 10240
    s_waitcnt lgkmcnt(0)
    s_cmp_ge_u32 s2, 8
    s_cbranch_scc1 S_ln_nt
    s_or_b32 s18, s18, 1
    v_mov_b32 v150, s18
    v_mov_b32 v151, 0
    s_mov_b64 exec, 1
    buffer_atomic_cmpswap v[150:151], v6, s[8:11], 0 offen
    s_mov_b64 exec, -1
S_ln_nt:
    buffer_load_dwordx4 v[16:19], v11, s[20:23], s15 offen offset:0
    buffer_load_dwordx4 v[20:23], v11, s[20:23], s15 offen offset:128
    buffer_load_dwordx4 v[24:27], v11, s[20:23], s15 offen offset:256
    buffer_load_dwordx4 v[28:31], v11, s[20:23], s15 offen offset:384
    buffer_load_dwordx4 v[32:35], v11, s[20:23], s15 offen offset:512
    buffer_load_dwordx4 v[36:39], v11, s[20:23], s15 offen offset:640
    buffer_load_dwordx4 v[40:43], v11, s[20:23], s15 offen offset:768
    buffer_load_dwordx4 v[44:47], v11, s[20:23], s15 offen offset:896
    buffer_load_dwordx4 v[48:51], v11, s[20:23], s15 offen offset:1024
    buffer_load_dwordx4 v[52:55], v11, s[20:23], s15 offen offset:1152
    v_mov_b32 v152, 0x3f803f80
    v_mov_b32 v136, 0
    s_waitcnt vmcnt(0)
    buffer_load_dword v7, v6, s[8:11], 0 offen sc1
    v_dot2_f32_bf16 v136, v16, v152, v136
    v_dot2_f32_bf16 v136, v17, v152, v136
    v_dot2_f32_bf16 v136, v18, v152, v136
    v_dot2_f32_bf16 v136, v19, v152, v136
    v_dot2_f32_bf16 v136, v20, v152, v136
    v_dot2_f32_bf16 v136, v21, v152, v136
    v_dot2_f32_bf16 v136, v22, v152, v136
    v_dot2_f32_bf16 v136, v23, v152, v136
    v_dot2_f32_bf16 v136, v24, v152, v136
    v_dot2_f32_bf16 v136, v25, v152, v136
    v_dot2_f32_bf16 v136, v26, v152, v136
    v_dot2_f32_bf16 v136, v27, v152, v136
    v_dot2_f32_bf16 v136, v28, v152, v136
    v_dot2_f32_bf16 v136, v29, v152, v136
    v_dot2_f32_bf16 v136, v30, v152, v136
    v_dot2_f32_bf16 v136, v31, v152, v136
    v_dot2_f32_bf16 v136, v32, v152, v136
    v_dot2_f32_bf16 v136, v33, v152, v136
    v_dot2_f32_bf16 v136, v34, v152, v136
    v_dot2_f32_bf16 v136, v35, v152, v136
    v_dot2_f32_bf16 v136, v36, v152, v136
    v_dot2_f32_bf16 v136, v37, v152, v136
    v_dot2_f32_bf16 v136, v38, v152, v136
    v_dot2_f32_bf16 v136, v39, v152, v136
    v_dot2_f32_bf16 v136, v40, v152, v136
    v_dot2_f32_bf16 v136, v41, v152, v136
    v_dot2_f32_bf16 v136, v42, v152, v136
    v_dot2_f32_bf16 v136, v43, v152, v136
    v_dot2_f32_bf16 v136, v44, v152, v136
    v_dot2_f32_bf16 v136, v45, v152, v136
    v_dot2_f32_bf16 v136, v46, v152, v136
    v_dot2_f32_bf16 v136, v47, v152, v136
    v_dot2_f32_bf16 v136, v48, v152, v136
    v_dot2_f32_bf16 v136, v49, v152, v136
    v_dot2_f32_bf16 v136, v50, v152, v136
    v_dot2_f32_bf16 v136, v51, v152, v136
    v_dot2_f32_bf16 v136, v52, v152, v136
    v_dot2_f32_bf16 v136, v53, v152, v136
    v_dot2_f32_bf16 v136, v54, v152, v136
    v_dot2_f32_bf16 v136, v55, v152, v136
    v_lshlrev_b32 v56, 16, v16
    v_and_b32 v57, 0xffff0000, v16
    v_lshlrev_b32 v58, 16, v17
    v_and_b32 v59, 0xffff0000, v17
    v_lshlrev_b32 v60, 16, v18
    v_and_b32 v61, 0xffff0000, v18
    v_lshlrev_b32 v62, 16, v19
    v_and_b32 v63, 0xffff0000, v19
    v_lshlrev_b32 v64, 16, v20
    v_and_b32 v65, 0xffff0000, v20
    v_lshlrev_b32 v66, 16, v21
    v_and_b32 v67, 0xffff0000, v21
    v_lshlrev_b32 v68, 16, v22
    v_and_b32 v69, 0xffff0000, v22
    v_lshlrev_b32 v70, 16, v23
    v_and_b32 v71, 0xffff0000, v23
    v_lshlrev_b32 v72, 16, v24
    v_and_b32 v73, 0xffff0000, v24
    v_lshlrev_b32 v74, 16, v25
    v_and_b32 v75, 0xffff0000, v25
    v_lshlrev_b32 v76, 16, v26
    v_and_b32 v77, 0xffff0000, v26
    v_lshlrev_b32 v78, 16, v27
    v_and_b32 v79, 0xffff0000, v27
    v_lshlrev_b32 v80, 16, v28
    v_and_b32 v81, 0xffff0000, v28
    v_lshlrev_b32 v82, 16, v29
    v_and_b32 v83, 0xffff0000, v29
    v_lshlrev_b32 v84, 16, v30
    v_and_b32 v85, 0xffff0000, v30
    v_lshlrev_b32 v86, 16, v31
    v_and_b32 v87, 0xffff0000, v31
    v_lshlrev_b32 v88, 16, v32
    v_and_b32 v89, 0xffff0000, v32
    v_lshlrev_b32 v90, 16, v33
    v_and_b32 v91, 0xffff0000, v33
    v_lshlrev_b32 v92, 16, v34
    v_and_b32 v93, 0xffff0000, v34
    v_lshlrev_b32 v94, 16, v35
    v_and_b32 v95, 0xffff0000, v35
    v_lshlrev_b32 v96, 16, v36
    v_and_b32 v97, 0xffff0000, v36
    v_lshlrev_b32 v98, 16, v37
    v_and_b32 v99, 0xffff0000, v37
    v_lshlrev_b32 v100, 16, v38
    v_and_b32 v101, 0xffff0000, v38
    v_lshlrev_b32 v102, 16, v39
    v_and_b32 v103, 0xffff0000, v39
    v_lshlrev_b32 v104, 16, v40
    v_and_b32 v105, 0xffff0000, v40
    v_lshlrev_b32 v106, 16, v41
    v_and_b32 v107, 0xffff0000, v41
    v_lshlrev_b32 v108, 16, v42
    v_and_b32 v109, 0xffff0000, v42
    v_lshlrev_b32 v110, 16, v43
    v_and_b32 v111, 0xffff0000, v43
    v_lshlrev_b32 v112, 16, v44
    v_and_b32 v113, 0xffff0000, v44
    v_lshlrev_b32 v114, 16, v45
    v_and_b32 v115, 0xffff0000, v45
    v_lshlrev_b32 v116, 16, v46
    v_and_b32 v117, 0xffff0000, v46
    v_lshlrev_b32 v118, 16, v47
    v_and_b32 v119, 0xffff0000, v47
    v_lshlrev_b32 v120, 16, v48
    v_and_b32 v121, 0xffff0000, v48
    v_lshlrev_b32 v122, 16, v49
    v_and_b32 v123, 0xffff0000, v49
    v_lshlrev_b32 v124, 16, v50
    v_and_b32 v125, 0xffff0000, v50
    v_lshlrev_b32 v126, 16, v51
    v_and_b32 v127, 0xffff0000, v51
    v_lshlrev_b32 v128, 16, v52
    v_and_b32 v129, 0xffff0000, v52
    v_lshlrev_b32 v130, 16, v53
    v_and_b32 v131, 0xffff0000, v53
    v_lshlrev_b32 v132, 16, v54
    v_and_b32 v133, 0xffff0000, v54
    v_lshlrev_b32 v134, 16, v55
    v_and_b32 v135, 0xffff0000, v55
    v_add_f32_dpp v136, v136, v136 quad_perm:[1,0,3,2] row_mask:0xf bank_mask:0xf
    s_nop 1
    v_add_f32_dpp v136, v136, v136 quad_perm:[2,3,0,1] row_mask:0xf bank_mask:0xf
    s_nop 1
    v_add_f32_dpp v136, v136, v136 row_half_mirror row_mask:0xf bank_mask:0xf
    v_mul_f32 v136, 0x3acccccd, v136
    v_cvt_pk_bf16_f32 v138, v136, v136
    v_and_b32 v138, 0xffff0000, v138
    v_mov_b32 v140, 0
    v_mov_b32 v141, 0
    v_sub_f32 v56, v56, v138
    v_fmac_f32 v140, v56, v56
    v_sub_f32 v57, v57, v138
    v_fmac_f32 v141, v57, v57
    v_sub_f32 v58, v58, v138
    v_fmac_f32 v140, v58, v58
    v_sub_f32 v59, v59, v138
    v_fmac_f32 v141, v59, v59
    v_sub_f32 v60, v60, v138
    v_fmac_f32 v140, v60, v60
    v_sub_f32 v61, v61, v138
    v_fmac_f32 v141, v61, v61
    v_sub_f32 v62, v62, v138
    v_fmac_f32 v140, v62, v62
    v_sub_f32 v63, v63, v138
    v_fmac_f32 v141, v63, v63
    v_sub_f32 v64, v64, v138
    v_fmac_f32 v140, v64, v64
    v_sub_f32 v65, v65, v138
    v_fmac_f32 v141, v65, v65
    v_sub_f32 v66, v66, v138
    v_fmac_f32 v140, v66, v66
    v_sub_f32 v67, v67, v138
    v_fmac_f32 v141, v67, v67
    v_sub_f32 v68, v68, v138
    v_fmac_f32 v140, v68, v68
    v_sub_f32 v69, v69, v138
    v_fmac_f32 v141, v69, v69
    v_sub_f32 v70, v70, v138
    v_fmac_f32 v140, v70, v70
    v_sub_f32 v71, v71, v138
    v_fmac_f32 v141, v71, v71
    v_sub_f32 v72, v72, v138
    v_fmac_f32 v140, v72, v72
    v_sub_f32 v73, v73, v138
    v_fmac_f32 v141, v73, v73
    v_sub_f32 v74, v74, v138
    v_fmac_f32 v140, v74, v74
    v_sub_f32 v75, v75, v138
    v_fmac_f32 v141, v75, v75
    v_sub_f32 v76, v76, v138
    v_fmac_f32 v140, v76, v76
    v_sub_f32 v77, v77, v138
    v_fmac_f32 v141, v77, v77
    v_sub_f32 v78, v78, v138
    v_fmac_f32 v140, v78, v78
    v_sub_f32 v79, v79, v138
    v_fmac_f32 v141, v79, v79
    v_sub_f32 v80, v80, v138
    v_fmac_f32 v140, v80, v80
    v_sub_f32 v81, v81, v138
    v_fmac_f32 v141, v81, v81
    v_sub_f32 v82, v82, v138
    v_fmac_f32 v140, v82, v82
    v_sub_f32 v83, v83, v138
    v_fmac_f32 v141, v83, v83
    v_sub_f32 v84, v84, v138
    v_fmac_f32 v140, v84, v84
    v_sub_f32 v85, v85, v138
    v_fmac_f32 v141, v85, v85
    v_sub_f32 v86, v86, v138
    v_fmac_f32 v140, v86, v86
    v_sub_f32 v87, v87, v138
    v_fmac_f32 v141, v87, v87
    v_sub_f32 v88, v88, v138
    v_fmac_f32 v140, v88, v88
    v_sub_f32 v89, v89, v138
    v_fmac_f32 v141, v89, v89
    v_sub_f32 v90, v90, v138
    v_fmac_f32 v140, v90, v90
    v_sub_f32 v91, v91, v138
    v_fmac_f32 v141, v91, v91
    v_sub_f32 v92, v92, v138
    v_fmac_f32 v140, v92, v92
    v_sub_f32 v93, v93, v138
    v_fmac_f32 v141, v93, v93
    v_sub_f32 v94, v94, v138
    v_fmac_f32 v140, v94, v94
    v_sub_f32 v95, v95, v138
    v_fmac_f32 v141, v95, v95
    v_sub_f32 v96, v96, v138
    v_fmac_f32 v140, v96, v96
    v_sub_f32 v97, v97, v138
    v_fmac_f32 v141, v97, v97
    v_sub_f32 v98, v98, v138
    v_fmac_f32 v140, v98, v98
    v_sub_f32 v99, v99, v138
    v_fmac_f32 v141, v99, v99
    v_sub_f32 v100, v100, v138
    v_fmac_f32 v140, v100, v100
    v_sub_f32 v101, v101, v138
    v_fmac_f32 v141, v101, v101
    v_sub_f32 v102, v102, v138
    v_fmac_f32 v140, v102, v102
    v_sub_f32 v103, v103, v138
    v_fmac_f32 v141, v103, v103
    v_sub_f32 v104, v104, v138
    v_fmac_f32 v140, v104, v104
    v_sub_f32 v105, v105, v138
    v_fmac_f32 v141, v105, v105
    v_sub_f32 v106, v106, v138
    v_fmac_f32 v140, v106, v106
    v_sub_f32 v107, v107, v138
    v_fmac_f32 v141, v107, v107
    v_sub_f32 v108, v108, v138
    v_fmac_f32 v140, v108, v108
    v_sub_f32 v109, v109, v138
    v_fmac_f32 v141, v109, v109
    v_sub_f32 v110, v110, v138
    v_fmac_f32 v140, v110, v110
    v_sub_f32 v111, v111, v138
    v_fmac_f32 v141, v111, v111
    v_sub_f32 v112, v112, v138
    v_fmac_f32 v140, v112, v112
    v_sub_f32 v113, v113, v138
    v_fmac_f32 v141, v113, v113
    v_sub_f32 v114, v114, v138
    v_fmac_f32 v140, v114, v114
    v_sub_f32 v115, v115, v138
    v_fmac_f32 v141, v115, v115
    v_sub_f32 v116, v116, v138
    v_fmac_f32 v140, v116, v116
    v_sub_f32 v117, v117, v138
    v_fmac_f32 v141, v117, v117
    v_sub_f32 v118, v118, v138
    v_fmac_f32 v140, v118, v118
    v_sub_f32 v119, v119, v138
    v_fmac_f32 v141, v119, v119
    v_sub_f32 v120, v120, v138
    v_fmac_f32 v140, v120, v120
    v_sub_f32 v121, v121, v138
    v_fmac_f32 v141, v121, v121
    v_sub_f32 v122, v122, v138
    v_fmac_f32 v140, v122, v122
    v_sub_f32 v123, v123, v138
    v_fmac_f32 v141, v123, v123
    v_sub_f32 v124, v124, v138
    v_fmac_f32 v140, v124, v124
    v_sub_f32 v125, v125, v138
    v_fmac_f32 v141, v125, v125
    v_sub_f32 v126, v126, v138
    v_fmac_f32 v140, v126, v126
    v_sub_f32 v127, v127, v138
    v_fmac_f32 v141, v127, v127
    v_sub_f32 v128, v128, v138
    v_fmac_f32 v140, v128, v128
    v_sub_f32 v129, v129, v138
    v_fmac_f32 v141, v129, v129
    v_sub_f32 v130, v130, v138
    v_fmac_f32 v140, v130, v130
    v_sub_f32 v131, v131, v138
    v_fmac_f32 v141, v131, v131
    v_sub_f32 v132, v132, v138
    v_fmac_f32 v140, v132, v132
    v_sub_f32 v133, v133, v138
    v_fmac_f32 v141, v133, v133
    v_sub_f32 v134, v134, v138
    v_fmac_f32 v140, v134, v134
    v_sub_f32 v135, v135, v138
    v_fmac_f32 v141, v135, v135
    v_add_f32 v140, v140, v141
    s_nop 1
    v_add_f32_dpp v140, v140, v140 quad_perm:[1,0,3,2] row_mask:0xf bank_mask:0xf
    s_nop 1
    v_add_f32_dpp v140, v140, v140 quad_perm:[2,3,0,1] row_mask:0xf bank_mask:0xf
    s_nop 1
    v_add_f32_dpp v140, v140, v140 row_half_mirror row_mask:0xf bank_mask:0xf
    v_sub_f32 v2, v136, v138
    v_mul_f32 v2, v2, v2
    v_mul_f32 v140, 0x3acccccd, v140
    v_sub_f32 v140, v140, v2
    v_max_f32 v140, 0, v140
    v_cvt_pk_bf16_f32 v140, v140, v140
    v_and_b32 v140, 0xffff0000, v140
    v_add_f32 v140, 0x3727c5ac, v140
    v_cvt_pk_bf16_f32 v140, v140, v140
    v_and_b32 v140, 0xffff0000, v140
    v_sqrt_f32 v140, v140
    s_nop 0
    v_cvt_pk_bf16_f32 v150, v138, v140
    v_and_b32 v140, 0xffff0000, v150
    v_rcp_f32 v140, v140
    s_nop 0
    v_mul_f32 v56, v56, v140
    v_mul_f32 v57, v57, v140
    v_cvt_pk_bf16_f32 v16, v56, v57
    v_mul_f32 v58, v58, v140
    v_mul_f32 v59, v59, v140
    v_cvt_pk_bf16_f32 v17, v58, v59
    v_mul_f32 v60, v60, v140
    v_mul_f32 v61, v61, v140
    v_cvt_pk_bf16_f32 v18, v60, v61
    v_mul_f32 v62, v62, v140
    v_mul_f32 v63, v63, v140
    v_cvt_pk_bf16_f32 v19, v62, v63
    ds_write_b128 v12, v[16:19] offset:0
    v_mul_f32 v64, v64, v140
    v_mul_f32 v65, v65, v140
    v_cvt_pk_bf16_f32 v20, v64, v65
    v_mul_f32 v66, v66, v140
    v_mul_f32 v67, v67, v140
    v_cvt_pk_bf16_f32 v21, v66, v67
    v_mul_f32 v68, v68, v140
    v_mul_f32 v69, v69, v140
    v_cvt_pk_bf16_f32 v22, v68, v69
    v_mul_f32 v70, v70, v140
    v_mul_f32 v71, v71, v140
    v_cvt_pk_bf16_f32 v23, v70, v71
    ds_write_b128 v12, v[20:23] offset:128
    v_mul_f32 v72, v72, v140
    v_mul_f32 v73, v73, v140
    v_cvt_pk_bf16_f32 v24, v72, v73
    v_mul_f32 v74, v74, v140
    v_mul_f32 v75, v75, v140
    v_cvt_pk_bf16_f32 v25, v74, v75
    v_mul_f32 v76, v76, v140
    v_mul_f32 v77, v77, v140
    v_cvt_pk_bf16_f32 v26, v76, v77
    v_mul_f32 v78, v78, v140
    v_mul_f32 v79, v79, v140
    v_cvt_pk_bf16_f32 v27, v78, v79
    ds_write_b128 v12, v[24:27] offset:256
    v_mul_f32 v80, v80, v140
    v_mul_f32 v81, v81, v140
    v_cvt_pk_bf16_f32 v28, v80, v81
    v_mul_f32 v82, v82, v140
    v_mul_f32 v83, v83, v140
    v_cvt_pk_bf16_f32 v29, v82, v83
    v_mul_f32 v84, v84, v140
    v_mul_f32 v85, v85, v140
    v_cvt_pk_bf16_f32 v30, v84, v85
    v_mul_f32 v86, v86, v140
    v_mul_f32 v87, v87, v140
    v_cvt_pk_bf16_f32 v31, v86, v87
    ds_write_b128 v12, v[28:31] offset:384
    v_mul_f32 v88, v88, v140
    v_mul_f32 v89, v89, v140
    v_cvt_pk_bf16_f32 v32, v88, v89
    v_mul_f32 v90, v90, v140
    v_mul_f32 v91, v91, v140
    v_cvt_pk_bf16_f32 v33, v90, v91
    v_mul_f32 v92, v92, v140
    v_mul_f32 v93, v93, v140
    v_cvt_pk_bf16_f32 v34, v92, v93
    v_mul_f32 v94, v94, v140
    v_mul_f32 v95, v95, v140
    v_cvt_pk_bf16_f32 v35, v94, v95
    ds_write_b128 v12, v[32:35] offset:512
    v_mul_f32 v96, v96, v140
    v_mul_f32 v97, v97, v140
    v_cvt_pk_bf16_f32 v36, v96, v97
    v_mul_f32 v98, v98, v140
    v_mul_f32 v99, v99, v140
    v_cvt_pk_bf16_f32 v37, v98, v99
    v_mul_f32 v100, v100, v140
    v_mul_f32 v101, v101, v140
    v_cvt_pk_bf16_f32 v38, v100, v101
    v_mul_f32 v102, v102, v140
    v_mul_f32 v103, v103, v140
    v_cvt_pk_bf16_f32 v39, v102, v103
    ds_write_b128 v12, v[36:39] offset:640
    v_mul_f32 v104, v104, v140
    v_mul_f32 v105, v105, v140
    v_cvt_pk_bf16_f32 v40, v104, v105
    v_mul_f32 v106, v106, v140
    v_mul_f32 v107, v107, v140
    v_cvt_pk_bf16_f32 v41, v106, v107
    v_mul_f32 v108, v108, v140
    v_mul_f32 v109, v109, v140
    v_cvt_pk_bf16_f32 v42, v108, v109
    v_mul_f32 v110, v110, v140
    v_mul_f32 v111, v111, v140
    v_cvt_pk_bf16_f32 v43, v110, v111
    ds_write_b128 v12, v[40:43] offset:768
    v_mul_f32 v112, v112, v140
    v_mul_f32 v113, v113, v140
    v_cvt_pk_bf16_f32 v44, v112, v113
    v_mul_f32 v114, v114, v140
    v_mul_f32 v115, v115, v140
    v_cvt_pk_bf16_f32 v45, v114, v115
    v_mul_f32 v116, v116, v140
    v_mul_f32 v117, v117, v140
    v_cvt_pk_bf16_f32 v46, v116, v117
    v_mul_f32 v118, v118, v140
    v_mul_f32 v119, v119, v140
    v_cvt_pk_bf16_f32 v47, v118, v119
    ds_write_b128 v12, v[44:47] offset:896
    v_mul_f32 v120, v120, v140
    v_mul_f32 v121, v121, v140
    v_cvt_pk_bf16_f32 v48, v120, v121
    v_mul_f32 v122, v122, v140
    v_mul_f32 v123, v123, v140
    v_cvt_pk_bf16_f32 v49, v122, v123
    v_mul_f32 v124, v124, v140
    v_mul_f32 v125, v125, v140
    v_cvt_pk_bf16_f32 v50, v124, v125
    v_mul_f32 v126, v126, v140
    v_mul_f32 v127, v127, v140
    v_cvt_pk_bf16_f32 v51, v126, v127
    ds_write_b128 v12, v[48:51] offset:1024
    v_mul_f32 v128, v128, v140
    v_mul_f32 v129, v129, v140
    v_cvt_pk_bf16_f32 v52, v128, v129
    v_mul_f32 v130, v130, v140
    v_mul_f32 v131, v131, v140
    v_cvt_pk_bf16_f32 v53, v130, v131
    v_mul_f32 v132, v132, v140
    v_mul_f32 v133, v133, v140
    v_cvt_pk_bf16_f32 v54, v132, v133
    v_mul_f32 v134, v134, v140
    v_mul_f32 v135, v135, v140
    v_cvt_pk_bf16_f32 v55, v134, v135
    ds_write_b128 v12, v[52:55] offset:1152
    v_bfe_u32 v3, v1, 2, 2
    v_mul_u32_u24 v3, 1344, v3
    v_lshrrev_b32 v2, 4, v1
    v_lshl_add_u32 v3, v2, 5, v3
    v_and_b32 v4, 3, v1
    v_lshl_add_u32 v3, v4, 3, v3
    v_add_u32 v13, 66048, v3
    s_mul_i32 s15, s17, 10240
    ds_read_b64_tr_b16 v[156:157], v13 offset:0
    ds_read_b64_tr_b16 v[158:159], v13 offset:5376
    ds_read_b64_tr_b16 v[160:161], v13 offset:128
    ds_read_b64_tr_b16 v[162:163], v13 offset:5504
    ds_read_b64_tr_b16 v[164:165], v13 offset:256
    ds_read_b64_tr_b16 v[166:167], v13 offset:5632
    ds_read_b64_tr_b16 v[168:169], v13 offset:384
    ds_read_b64_tr_b16 v[170:171], v13 offset:5760
    s_waitcnt lgkmcnt(6)
    buffer_store_dwordx4 v[156:159], v8, s[4:7], s15 offen sc1
    s_add_u32 s15, s15, 1024
    ds_read_b64_tr_b16 v[156:157], v13 offset:512
    ds_read_b64_tr_b16 v[158:159], v13 offset:5888
    s_waitcnt lgkmcnt(6)
    buffer_store_dwordx4 v[160:163], v8, s[4:7], s15 offen sc1
    s_add_u32 s15, s15, 1024
    ds_read_b64_tr_b16 v[160:161], v13 offset:640
    ds_read_b64_tr_b16 v[162:163], v13 offset:6016
    s_waitcnt lgkmcnt(6)
    buffer_store_dwordx4 v[164:167], v8, s[4:7], s15 offen sc1
    s_add_u32 s15, s15, 1024
    ds_read_b64_tr_b16 v[164:165], v13 offset:768
    ds_read_b64_tr_b16 v[166:167], v13 offset:6144
    s_waitcnt lgkmcnt(6)
    buffer_store_dwordx4 v[168:171], v8, s[4:7], s15 offen sc1
    s_add_u32 s15, s15, 1024
    ds_read_b64_tr_b16 v[168:169], v13 offset:896
    ds_read_b64_tr_b16 v[170:171], v13 offset:6272
    s_waitcnt lgkmcnt(6)
    buffer_store_dwordx4 v[156:159], v8, s[4:7], s15 offen sc1
    s_add_u32 s15, s15, 1024
    ds_read_b64_tr_b16 v[156:157], v13 offset:1024
    ds_read_b64_tr_b16 v[158:159], v13 offset:6400
    s_waitcnt lgkmcnt(6)
    buffer_store_dwordx4 v[160:163], v8, s[4:7], s15 offen sc1
    s_add_u32 s15, s15, 1024
    ds_read_b64_tr_b16 v[160:161], v13 offset:1152
    ds_read_b64_tr_b16 v[162:163], v13 offset:6528
    s_waitcnt lgkmcnt(6)
    buffer_store_dwordx4 v[164:167], v8, s[4:7], s15 offen sc1
    s_add_u32 s15, s15, 1024
    s_waitcnt lgkmcnt(4)
    buffer_store_dwordx4 v[168:171], v8, s[4:7], s15 offen sc1
    s_add_u32 s15, s15, 1024
    s_waitcnt lgkmcnt(2)
    buffer_store_dwordx4 v[156:159], v8, s[4:7], s15 offen sc1
    s_add_u32 s15, s15, 1024
    s_waitcnt lgkmcnt(0)
    buffer_store_dwordx4 v[160:163], v8, s[4:7], s15 offen sc1
    s_add_u32 s15, s15, 1024
    s_waitcnt vmcnt(10)
    v_readfirstlane_b32 s13, v7
    s_nop 0
    s_cmp_lg_u32 s13, 0
    s_cbranch_scc1 TK_13
    s_mov_b32 s14, 0
TL_14:
    s_sleep 2
    buffer_load_dword v7, v6, s[8:11], 0 offen sc1
    s_waitcnt vmcnt(0)
    v_readfirstlane_b32 s13, v7
    s_nop 0
    s_cmp_lg_u32 s13, 0
    s_cbranch_scc1 TK_13
    s_add_u32 s14, s14, 1
    s_cmp_lt_u32 s14, 16384
    s_cbranch_scc1 TL_14
TK_13:
    v_mov_b32 v151, s13
    s_lshl_b32 s15, s17, 7
    s_add_u32 s16, s15, 20971520
    s_mov_b32 exec_lo, 0x01010101
    s_mov_b32 exec_hi, 0x01010101
    buffer_store_dwordx2 v[150:151], v1, s[4:7], s16 offen sc1
    s_add_u32 s15, s15, 22020096
    s_waitcnt vmcnt(0)
    s_mov_b64 exec, 1
    buffer_store_dword v151, v6, s[4:7], s15 offen sc1
    s_mov_b64 exec, -1
    v_mul_u32_u24 v2, 10240, v1
    v_lshlrev_b32 v3, 7, v1
    s_cmp_eq_u32 s57, 0
    s_cselect_b32 s29, s26, s28
    s_lshl_b32 s17, s2, 7
    s_add_u32 s17, s17, 22085632
    s_mov_b32 s14, 0
    s_mov_b64 exec, 1
S_pace:
    s_sleep 8
    buffer_load_dword v4, v6, s[4:7], s17 offen sc1
    s_waitcnt vmcnt(0)
    v_readfirstlane_b32 s15, v4
    s_nop 0
    s_cmp_eq_u32 s15, s13
    s_cbranch_scc1 S_paced
    s_add_u32 s14, s14, 1
    s_cmp_lt_u32 s14, 24
    s_cbranch_scc1 S_pace
S_paced:
    s_mov_b64 exec, -1
    s_mov_b32 s17, 22020096
    buffer_load_dword v156, v3, s[4:7], s17 offen sc1
    s_mov_b32 s17, 22028288
    buffer_load_dword v157, v3, s[4:7], s17 offen sc1
    s_mov_b32 s17, 22036480
    buffer_load_dword v158, v3, s[4:7], s17 offen sc1
    s_mov_b32 s17, 22044672
    buffer_load_dword v159, v3, s[4:7], s17 offen sc1
    s_waitcnt vmcnt(0)
    s_mov_b32 s17, 22020096
    v_cmp_ne_u32 vcc, s13, v156
    s_nop 0
    s_cmp_eq_u64 vcc, 0
    s_cbranch_scc1 FD_15
    s_mov_b32 s14, 0
FL_16:
    s_sleep 6
    s_mov_b64 exec, vcc
    buffer_load_dword v156, v3, s[4:7], s17 offen sc1
    s_mov_b64 exec, -1
    s_waitcnt vmcnt(0)
    v_cmp_ne_u32 vcc, s13, v156
    s_nop 0
    s_cmp_eq_u64 vcc, 0
    s_cbranch_scc1 FD_15
    s_add_u32 s14, s14, 1
    s_cmp_lt_u32 s14, 16384
    s_cbranch_scc1 FL_16
FD_15:
    s_mov_b32 s17, 22028288
    v_cmp_ne_u32 vcc, s13, v157
    s_nop 0
    s_cmp_eq_u64 vcc, 0
    s_cbranch_scc1 FD_17
    s_mov_b32 s14, 0
FL_18:
    s_sleep 6
    s_mov_b64 exec, vcc
    buffer_load_dword v157, v3, s[4:7], s17 offen sc1
    s_mov_b64 exec, -1
    s_waitcnt vmcnt(0)
    v_cmp_ne_u32 vcc, s13, v157
    s_nop 0
    s_cmp_eq_u64 vcc, 0
    s_cbranch_scc1 FD_17
    s_add_u32 s14, s14, 1
    s_cmp_lt_u32 s14, 16384
    s_cbranch_scc1 FL_18
FD_17:
    s_mov_b32 s17, 22036480
    v_cmp_ne_u32 vcc, s13, v158
    s_nop 0
    s_cmp_eq_u64 vcc, 0
    s_cbranch_scc1 FD_19
    s_mov_b32 s14, 0
FL_20:
    s_sleep 6
    s_mov_b64 exec, vcc
    buffer_load_dword v158, v3, s[4:7], s17 offen sc1
    s_mov_b64 exec, -1
    s_waitcnt vmcnt(0)
    v_cmp_ne_u32 vcc, s13, v158
    s_nop 0
    s_cmp_eq_u64 vcc, 0
    s_cbranch_scc1 FD_19
    s_add_u32 s14, s14, 1
    s_cmp_lt_u32 s14, 16384
    s_cbranch_scc1 FL_20
FD_19:
    s_mov_b32 s17, 22044672
    v_cmp_ne_u32 vcc, s13, v159
    s_nop 0
    s_cmp_eq_u64 vcc, 0
    s_cbranch_scc1 FD_21
    s_mov_b32 s14, 0
FL_22:
    s_sleep 6
    s_mov_b64 exec, vcc
    buffer_load_dword v159, v3, s[4:7], s17 offen sc1
    s_mov_b64 exec, -1
    s_waitcnt vmcnt(0)
    v_cmp_ne_u32 vcc, s13, v159
    s_nop 0
    s_cmp_eq_u64 vcc, 0
    s_cbranch_scc1 FD_21
    s_add_u32 s14, s14, 1
    s_cmp_lt_u32 s14, 16384
    s_cbranch_scc1 FL_22
FD_21:
    v_lshrrev_b32 v3, 1, v1
    v_and_b32 v5, 1, v1
    v_mul_u32_u24 v4, 10240, v3
    v_lshl_add_u32 v4, v5, 4, v4
    v_mul_u32_u24 v5, 4608, v5
    v_lshl_add_u32 v5, v3, 4, v5
    s_lshl_b32 s15, s26, 4
    buffer_load_dwordx4 v[56:59], v4, s[4:7], s15 offen sc1
    s_add_u32 s15, s15, 327680
    buffer_load_dwordx4 v[60:63], v4, s[4:7], s15 offen sc1
    s_add_u32 s15, s15, 327680
    buffer_load_dwordx4 v[64:67], v4, s[4:7], s15 offen sc1
    s_add_u32 s15, s15, 327680
    buffer_load_dwordx4 v[68:71], v4, s[4:7], s15 offen sc1
    s_add_u32 s15, s15, 327680
    buffer_load_dwordx4 v[72:75], v4, s[4:7], s15 offen sc1
    s_add_u32 s15, s15, 327680
    buffer_load_dwordx4 v[76:79], v4, s[4:7], s15 offen sc1
    s_add_u32 s15, s15, 327680
    buffer_load_dwordx4 v[80:83], v4, s[4:7], s15 offen sc1
    s_add_u32 s15, s15, 327680
    buffer_load_dwordx4 v[84:87], v4, s[4:7], s15 offen sc1
    s_cmp_eq_u32 s57, 0
    s_cbranch_scc1 S_g2
    s_lshl_b32 s15, s28, 4
    buffer_load_dwordx4 v[88:91], v2, s[4:7], s15 offen sc1
    s_add_u32 s15, s15, 655360
    buffer_load_dwordx4 v[92:95], v2, s[4:7], s15 offen sc1
    s_add_u32 s15, s15, 655360
    buffer_load_dwordx4 v[96:99], v2, s[4:7], s15 offen sc1
    s_add_u32 s15, s15, 655360
    buffer_load_dwordx4 v[100:103], v2, s[4:7], s15 offen sc1
    s_waitcnt vmcnt(0)
    ds_write_b128 v8, v[88:91] offset:61952
    ds_write_b128 v8, v[92:95] offset:62976
    ds_write_b128 v8, v[96:99] offset:64000
    ds_write_b128 v8, v[100:103] offset:65024
S_g2:
    s_waitcnt vmcnt(7)
    ds_write_b128 v5, v[56:59] offset:52736
    s_waitcnt vmcnt(6)
    ds_write_b128 v5, v[60:63] offset:53248
    s_waitcnt vmcnt(5)
    ds_write_b128 v5, v[64:67] offset:53760
    s_waitcnt vmcnt(4)
    ds_write_b128 v5, v[68:71] offset:54272
    s_waitcnt vmcnt(3)
    ds_write_b128 v5, v[72:75] offset:54784
    s_waitcnt vmcnt(2)
    ds_write_b128 v5, v[76:79] offset:55296
    s_waitcnt vmcnt(1)
    ds_write_b128 v5, v[80:83] offset:55808
    s_waitcnt vmcnt(0)
    ds_write_b128 v5, v[84:87] offset:56320
S_join:
    s_and_b32 s30, s12, 1
    v_mov_b32 v120, 0
    v_mov_b32 v121, 0
    v_mov_b32 v122, 0
    v_mov_b32 v123, 0
    s_min_u32 s15, s12, 2
    s_mul_i32 s15, s15, 4608
    v_add_u32 v4, s15, v8
    s_mov_b32 exec_hi, 0
    ds_write_b128 v4, v[120:123] offset:52224
    s_mov_b32 exec_hi, -1
    v_and_b32 v2, 15, v1
    v_sub_u32 v4, 15, v2
    v_and_b32 v5, 3, v4
    v_sub_u32 v4, v4, v5
    v_mul_u32_u24 v5, 4160, v5
    v_lshl_add_u32 v5, v4, 1, v5
    v_lshrrev_b32 v4, 4, v1
    v_lshl_add_u32 v174, v4, 4, v5
    v_lshlrev_b32 v5, 4, v4
    v_lshl_add_u32 v175, v2, 5, v5
    v_lshrrev_b32 v5, 1, v4
    v_lshlrev_b32 v5, 3, v5
    v_xor_b32 v5, v5, v2
    v_lshlrev_b32 v5, 4, v5
    v_lshl_add_u32 v5, v4, 8, v5
    s_lshl_b32 s15, s12, 13
    v_add_u32 v176, s15, v5
    v_bfe_u32 v2, v1, 1, 4
    v_and_b32 v4, 1, v1
    v_lshlrev_b32 v5, 3, v4
    v_xor_b32 v2, v2, v5
    v_lshlrev_b32 v2, 4, v2
    v_lshl_add_u32 v2, v4, 9, v2
    v_lshrrev_b32 v4, 5, v1
    v_lshl_add_u32 v177, v4, 10, v2
    v_mov_b32 v180, s13
    s_mul_i32 s15, s31, 17408
    s_lshl_b32 s16, s30, 8
    s_sub_u32 s15, s15, s16
    s_add_u32 s15, s15, 448
    v_add_u32 v172, s15, v174
    s_mul_i32 s15, s31, 4608
    s_sub_u32 s15, s15, s16
    s_add_u32 s15, s15, 52704
    v_add_u32 v173, s15, v175
    s_lshl_b32 s17, s12, 7
    s_sub_u32 s23, s15, 192
    s_sub_u32 s23, s23, 61920
    s_add_u32 s23, s23, s17
    s_mul_i32 s22, s31, 17408
    s_sub_u32 s22, s22, s16
    s_sub_u32 s22, s22, 35008
    s_add_u32 s22, s22, s17
    v_mov_b32 v12, 0
    v_mov_b32 v184, 0
    v_mov_b32 v13, 0
    v_mov_b32 v185, 0
    v_mov_b32 v14, 0
    v_mov_b32 v186, 0
    v_mov_b32 v15, 0
    v_mov_b32 v187, 0
    v_mov_b32 v16, 0
    v_mov_b32 v188, 0
    v_mov_b32 v17, 0
    v_mov_b32 v189, 0
    v_mov_b32 v18, 0
    v_mov_b32 v190, 0
    v_mov_b32 v19, 0
    v_mov_b32 v191, 0
    v_mov_b32 v20, 0
    v_mov_b32 v192, 0
    v_mov_b32 v21, 0
    v_mov_b32 v193, 0
    v_mov_b32 v22, 0
    v_mov_b32 v194, 0
    v_mov_b32 v23, 0
    v_mov_b32 v195, 0
    v_mov_b32 v24, 0
    v_mov_b32 v196, 0
    v_mov_b32 v25, 0
    v_mov_b32 v197, 0
    v_mov_b32 v26, 0
    v_mov_b32 v198, 0
    v_mov_b32 v27, 0
    v_mov_b32 v199, 0
    v_mov_b32 v28, 0
    v_mov_b32 v200, 0
    v_mov_b32 v29, 0
    v_mov_b32 v201, 0
    v_mov_b32 v30, 0
    v_mov_b32 v202, 0
    v_mov_b32 v31, 0
    v_mov_b32 v203, 0
    v_mov_b32 v32, 0
    v_mov_b32 v204, 0
    v_mov_b32 v33, 0
    v_mov_b32 v205, 0
    v_mov_b32 v34, 0
    v_mov_b32 v206, 0
    v_mov_b32 v35, 0
    v_mov_b32 v207, 0
    v_mov_b32 v36, 0
    v_mov_b32 v208, 0
    v_mov_b32 v37, 0
    v_mov_b32 v209, 0
    v_mov_b32 v38, 0
    v_mov_b32 v210, 0
    v_mov_b32 v39, 0
    v_mov_b32 v211, 0
    v_mov_b32 v40, 0
    v_mov_b32 v212, 0
    v_mov_b32 v41, 0
    v_mov_b32 v213, 0
    v_mov_b32 v42, 0
    v_mov_b32 v214, 0
    v_mov_b32 v43, 0
    v_mov_b32 v215, 0
    s_mov_b32 s29, 0
    s_add_u32 s56, s57, 2
    s_waitcnt vmcnt(0) lgkmcnt(0)
    s_barrier
    ds_read_b128 v[108:111], v173 offset:0
    ds_read_b64 v[44:45], v172 offset:3584
    ds_read_b64 v[46:47], v172 offset:3592
    ds_read_b128 v[112:115], v173 offset:512
    ds_read_b64 v[48:49], v172 offset:3072
    ds_read_b64 v[50:51], v172 offset:3080
    ds_read_b128 v[116:119], v173 offset:1024
    ds_read_b64 v[52:53], v172 offset:2560
    ds_read_b64 v[54:55], v172 offset:2568
    ds_read_b128 v[120:123], v173 offset:1536
    ds_read_b64 v[56:57], v172 offset:2048
    ds_read_b64 v[58:59], v172 offset:2056
    ds_read_b128 v[124:127], v173 offset:2048
    ds_read_b64 v[60:61], v172 offset:1536
    ds_read_b64 v[62:63], v172 offset:1544
    ds_read_b128 v[128:131], v173 offset:2560
    ds_read_b64 v[64:65], v172 offset:1024
    ds_read_b64 v[66:67], v172 offset:1032
    ds_read_b128 v[132:135], v173 offset:3072
    ds_read_b64 v[68:69], v172 offset:512
    ds_read_b64 v[70:71], v172 offset:520
    ds_read_b128 v[136:139], v173 offset:3584
    ds_read_b64 v[72:73], v172 offset:0
    ds_read_b64 v[74:75], v172 offset:8
    v_subrev_u32 v172, 64, v172
    v_subrev_u32 v173, 64, v173
CV_loop:
    s_cmp_eq_u32 s29, 1
    s_cselect_b32 s20, s22, 64
    s_cselect_b32 s21, s23, 64
    s_waitcnt lgkmcnt(0)
    v_mfma_f32_16x16x32_bf16 v[12:15], v[44:47], v[108:111], v[12:15]
    ds_read_b128 v[140:143], v173 offset:0
    v_mfma_f32_16x16x32_bf16 v[16:19], v[44:47], v[112:115], v[16:19]
    ds_read_b64 v[76:77], v172 offset:3584
    v_mfma_f32_16x16x32_bf16 v[16:19], v[48:51], v[108:111], v[16:19]
    ds_read_b64 v[78:79], v172 offset:3592
    v_mfma_f32_16x16x32_bf16 v[20:23], v[48:51], v[112:115], v[20:23]
    ds_read_b128 v[144:147], v173 offset:512
    v_mfma_f32_16x16x32_bf16 v[20:23], v[44:47], v[116:119], v[20:23]
    ds_read_b64 v[80:81], v172 offset:3072
    v_mfma_f32_16x16x32_bf16 v[20:23], v[52:55], v[108:111], v[20:23]
    ds_read_b64 v[82:83], v172 offset:3080
    v_mfma_f32_16x16x32_bf16 v[24:27], v[48:51], v[116:119], v[24:27]
    ds_read_b128 v[148:151], v173 offset:1024
    v_mfma_f32_16x16x32_bf16 v[24:27], v[52:55], v[112:115], v[24:27]
    ds_read_b64 v[84:85], v172 offset:2560
    v_mfma_f32_16x16x32_bf16 v[28:31], v[52:55], v[116:119], v[28:31]
    ds_read_b64 v[86:87], v172 offset:2568
    v_mfma_f32_16x16x32_bf16 v[24:27], v[44:47], v[120:123], v[24:27]
    ds_read_b128 v[152:155], v173 offset:1536
    v_mfma_f32_16x16x32_bf16 v[24:27], v[56:59], v[108:111], v[24:27]
    ds_read_b64 v[88:89], v172 offset:2048
    v_mfma_f32_16x16x32_bf16 v[28:31], v[48:51], v[120:123], v[28:31]
    ds_read_b64 v[90:91], v172 offset:2056
    v_mfma_f32_16x16x32_bf16 v[28:31], v[56:59], v[112:115], v[28:31]
    ds_read_b128 v[156:159], v173 offset:2048
    v_mfma_f32_16x16x32_bf16 v[32:35], v[52:55], v[120:123], v[32:35]
    ds_read_b64 v[92:93], v172 offset:1536
    v_mfma_f32_16x16x32_bf16 v[32:35], v[56:59], v[116:119], v[32:35]
    ds_read_b64 v[94:95], v172 offset:1544
    v_mfma_f32_16x16x32_bf16 v[36:39], v[56:59], v[120:123], v[36:39]
    ds_read_b128 v[160:163], v173 offset:2560
    v_mfma_f32_16x16x32_bf16 v[28:31], v[44:47], v[124:127], v[28:31]
    ds_read_b64 v[96:97], v172 offset:1024
    v_mfma_f32_16x16x32_bf16 v[28:31], v[60:63], v[108:111], v[28:31]
    ds_read_b64 v[98:99], v172 offset:1032
    v_mfma_f32_16x16x32_bf16 v[32:35], v[48:51], v[124:127], v[32:35]
    ds_read_b128 v[164:167], v173 offset:3072
    v_mfma_f32_16x16x32_bf16 v[32:35], v[60:63], v[112:115], v[32:35]
    ds_read_b64 v[100:101], v172 offset:512
    v_mfma_f32_16x16x32_bf16 v[36:39], v[52:55], v[124:127], v[36:39]
    ds_read_b64 v[102:103], v172 offset:520
    v_mfma_f32_16x16x32_bf16 v[36:39], v[60:63], v[116:119], v[36:39]
    ds_read_b128 v[168:171], v173 offset:3584
    v_mfma_f32_16x16x32_bf16 v[40:43], v[56:59], v[124:127], v[40:43]
    ds_read_b64 v[104:105], v172 offset:0
    v_mfma_f32_16x16x32_bf16 v[40:43], v[60:63], v[120:123], v[40:43]
    ds_read_b64 v[106:107], v172 offset:8
    v_mfma_f32_16x16x32_bf16 v[32:35], v[44:47], v[128:131], v[32:35]
    v_subrev_u32 v172, s20, v172
    v_mfma_f32_16x16x32_bf16 v[32:35], v[64:67], v[108:111], v[32:35]
    v_subrev_u32 v173, s21, v173
    v_mfma_f32_16x16x32_bf16 v[36:39], v[48:51], v[128:131], v[36:39]
    v_mfma_f32_16x16x32_bf16 v[36:39], v[64:67], v[112:115], v[36:39]
    v_mfma_f32_16x16x32_bf16 v[40:43], v[52:55], v[128:131], v[40:43]
    v_mfma_f32_16x16x32_bf16 v[40:43], v[64:67], v[116:119], v[40:43]
    v_mfma_f32_16x16x32_bf16 v[36:39], v[44:47], v[132:135], v[36:39]
    v_mfma_f32_16x16x32_bf16 v[36:39], v[68:71], v[108:111], v[36:39]
    v_mfma_f32_16x16x32_bf16 v[40:43], v[48:51], v[132:135], v[40:43]
    v_mfma_f32_16x16x32_bf16 v[40:43], v[68:71], v[112:115], v[40:43]
    v_mfma_f32_16x16x32_bf16 v[40:43], v[44:47], v[136:139], v[40:43]
    v_mfma_f32_16x16x32_bf16 v[40:43], v[72:75], v[108:111], v[40:43]
    s_waitcnt lgkmcnt(0)
    v_mfma_f32_16x16x32_bf16 v[12:15], v[76:79], v[140:143], v[12:15]
    ds_read_b128 v[108:111], v173 offset:0
    v_mfma_f32_16x16x32_bf16 v[16:19], v[76:79], v[144:147], v[16:19]
    ds_read_b64 v[44:45], v172 offset:3584
    v_mfma_f32_16x16x32_bf16 v[16:19], v[80:83], v[140:143], v[16:19]
    ds_read_b64 v[46:47], v172 offset:3592
    v_mfma_f32_16x16x32_bf16 v[20:23], v[80:83], v[144:147], v[20:23]
    ds_read_b128 v[112:115], v173 offset:512
    v_mfma_f32_16x16x32_bf16 v[20:23], v[76:79], v[148:151], v[20:23]
    ds_read_b64 v[48:49], v172 offset:3072
    v_mfma_f32_16x16x32_bf16 v[20:23], v[84:87], v[140:143], v[20:23]
    ds_read_b64 v[50:51], v172 offset:3080
    v_mfma_f32_16x16x32_bf16 v[24:27], v[80:83], v[148:151], v[24:27]
    ds_read_b128 v[116:119], v173 offset:1024
    v_mfma_f32_16x16x32_bf16 v[24:27], v[84:87], v[144:147], v[24:27]
    ds_read_b64 v[52:53], v172 offset:2560
    v_mfma_f32_16x16x32_bf16 v[28:31], v[84:87], v[148:151], v[28:31]
    ds_read_b64 v[54:55], v172 offset:2568
    v_mfma_f32_16x16x32_bf16 v[24:27], v[76:79], v[152:155], v[24:27]
    ds_read_b128 v[120:123], v173 offset:1536
    v_mfma_f32_16x16x32_bf16 v[24:27], v[88:91], v[140:143], v[24:27]
    ds_read_b64 v[56:57], v172 offset:2048
    v_mfma_f32_16x16x32_bf16 v[28:31], v[80:83], v[152:155], v[28:31]
    ds_read_b64 v[58:59], v172 offset:2056
    v_mfma_f32_16x16x32_bf16 v[28:31], v[88:91], v[144:147], v[28:31]
    ds_read_b128 v[124:127], v173 offset:2048
    v_mfma_f32_16x16x32_bf16 v[32:35], v[84:87], v[152:155], v[32:35]
    ds_read_b64 v[60:61], v172 offset:1536
    v_mfma_f32_16x16x32_bf16 v[32:35], v[88:91], v[148:151], v[32:35]
    ds_read_b64 v[62:63], v172 offset:1544
    v_mfma_f32_16x16x32_bf16 v[36:39], v[88:91], v[152:155], v[36:39]
    ds_read_b128 v[128:131], v173 offset:2560
    v_mfma_f32_16x16x32_bf16 v[28:31], v[76:79], v[156:159], v[28:31]
    ds_read_b64 v[64:65], v172 offset:1024
    v_mfma_f32_16x16x32_bf16 v[28:31], v[92:95], v[140:143], v[28:31]
    ds_read_b64 v[66:67], v172 offset:1032
    v_mfma_f32_16x16x32_bf16 v[32:35], v[80:83], v[156:159], v[32:35]
    ds_read_b128 v[132:135], v173 offset:3072
    v_mfma_f32_16x16x32_bf16 v[32:35], v[92:95], v[144:147], v[32:35]
    ds_read_b64 v[68:69], v172 offset:512
    v_mfma_f32_16x16x32_bf16 v[36:39], v[84:87], v[156:159], v[36:39]
    ds_read_b64 v[70:71], v172 offset:520
    v_mfma_f32_16x16x32_bf16 v[36:39], v[92:95], v[148:151], v[36:39]
    ds_read_b128 v[136:139], v173 offset:3584
    v_mfma_f32_16x16x32_bf16 v[40:43], v[88:91], v[156:159], v[40:43]
    ds_read_b64 v[72:73], v172 offset:0
    v_mfma_f32_16x16x32_bf16 v[40:43], v[92:95], v[152:155], v[40:43]
    ds_read_b64 v[74:75], v172 offset:8
    v_mfma_f32_16x16x32_bf16 v[32:35], v[76:79], v[160:163], v[32:35]
    v_subrev_u32 v172, 64, v172
    v_mfma_f32_16x16x32_bf16 v[32:35], v[96:99], v[140:143], v[32:35]
    v_subrev_u32 v173, 64, v173
    v_mfma_f32_16x16x32_bf16 v[36:39], v[80:83], v[160:163], v[36:39]
    v_mfma_f32_16x16x32_bf16 v[36:39], v[96:99], v[144:147], v[36:39]
    v_mfma_f32_16x16x32_bf16 v[40:43], v[84:87], v[160:163], v[40:43]
    v_mfma_f32_16x16x32_bf16 v[40:43], v[96:99], v[148:151], v[40:43]
    v_mfma_f32_16x16x32_bf16 v[36:39], v[76:79], v[164:167], v[36:39]
    v_mfma_f32_16x16x32_bf16 v[36:39], v[100:103], v[140:143], v[36:39]
    v_mfma_f32_16x16x32_bf16 v[40:43], v[80:83], v[164:167], v[40:43]
    v_mfma_f32_16x16x32_bf16 v[40:43], v[100:103], v[144:147], v[40:43]
    v_mfma_f32_16x16x32_bf16 v[40:43], v[76:79], v[168:171], v[40:43]
    v_mfma_f32_16x16x32_bf16 v[40:43], v[104:107], v[140:143], v[40:43]
    s_add_u32 s29, s29, 1
    s_cmp_eq_u32 s29, 1
    s_cbranch_scc1 CV_loop
    s_cmp_eq_u32 s29, 3
    s_cbranch_scc1 CV_done
    v_swap_b32 v12, v184
    v_swap_b32 v13, v185
    v_swap_b32 v14, v186
    v_swap_b32 v15, v187
    v_swap_b32 v16, v188
    v_swap_b32 v17, v189
    v_swap_b32 v18, v190
    v_swap_b32 v19, v191
    v_swap_b32 v20, v192
    v_swap_b32 v21, v193
    v_swap_b32 v22, v194
    v_swap_b32 v23, v195
    v_swap_b32 v24, v196
    v_swap_b32 v25, v197
    v_swap_b32 v26, v198
    v_swap_b32 v27, v199
    v_swap_b32 v28, v200
    v_swap_b32 v29, v201
    v_swap_b32 v30, v202
    v_swap_b32 v31, v203
    v_swap_b32 v32, v204
    v_swap_b32 v33, v205
    v_swap_b32 v34, v206
    v_swap_b32 v35, v207
    v_swap_b32 v36, v208
    v_swap_b32 v37, v209
    v_swap_b32 v38, v210
    v_swap_b32 v39, v211
    v_swap_b32 v40, v212
    v_swap_b32 v41, v213
    v_swap_b32 v42, v214
    v_swap_b32 v43, v215
    s_cmp_lg_u32 s57, 0
    s_nop 0
    s_cbranch_scc1 CV_loop
CV_done:
    s_nop 7
    s_waitcnt lgkmcnt(0)
    s_barrier
    ds_write_b128 v176, v[184:187] offset:0
    ds_write_b128 v176, v[188:191] offset:1024
    ds_write_b128 v176, v[192:195] offset:2048
    ds_write_b128 v176, v[196:199] offset:3072
    ds_write_b128 v176, v[200:203] offset:4096
    ds_write_b128 v176, v[204:207] offset:5120
    ds_write_b128 v176, v[208:211] offset:6144
    ds_write_b128 v176, v[212:215] offset:7168
    s_cmp_eq_u32 s57, 0
    s_cbranch_scc1 CV_w1
    ds_write_b128 v176, v[12:15] offset:32768
    ds_write_b128 v176, v[16:19] offset:33792
    ds_write_b128 v176, v[20:23] offset:34816
    ds_write_b128 v176, v[24:27] offset:35840
    ds_write_b128 v176, v[28:31] offset:36864
    ds_write_b128 v176, v[32:35] offset:37888
    ds_write_b128 v176, v[36:39] offset:38912
    ds_write_b128 v176, v[40:43] offset:39936
CV_w1:
    s_lshl_b32 s15, s31, 14
    s_lshl_b32 s16, s30, 12
    s_add_u32 s15, s15, s16
    v_add_u32 v2, s15, v177
    s_lshl_b32 s15, s12, 11
    v_add_u32 v3, s15, v177
    s_add_u32 s15, s26, s31
    s_lshl_b32 s17, s15, 12
    s_lshl_b32 s16, s30, 11
    s_add_u32 s17, s17, s16
    s_add_u32 s17, s17, 4194304
    s_lshl_b32 s15, s15, 7
    s_lshl_b32 s16, s30, 3
    s_add_u32 s15, s15, s16
    s_add_u32 s22, s15, 22413312
    v_lshlrev_b32 v4, 2, v1
    s_waitcnt lgkmcnt(0)
    s_barrier
    ds_read_b128 v[76:79], v2 offset:0
    ds_read_b128 v[80:83], v2 offset:256
    ds_read_b128 v[84:87], v2 offset:8192
    ds_read_b128 v[88:91], v2 offset:8448
    ds_read_b128 v[92:95], v2 offset:2048
    ds_read_b128 v[96:99], v2 offset:2304
    ds_read_b128 v[100:103], v2 offset:10240
    ds_read_b128 v[104:107], v2 offset:10496
    ds_read_b128 v[44:47], v3 offset:32768
    ds_read_b128 v[48:51], v3 offset:33024
    ds_read_b128 v[52:55], v3 offset:40960
    ds_read_b128 v[56:59], v3 offset:41216
    ds_read_b128 v[60:63], v3 offset:49152
    ds_read_b128 v[64:67], v3 offset:49408
    ds_read_b128 v[68:71], v3 offset:57344
    ds_read_b128 v[72:75], v3 offset:57600
    s_waitcnt lgkmcnt(12)
    v_add_f32 v76, v76, v84
    v_add_f32 v77, v77, v85
    v_add_f32 v78, v78, v86
    v_add_f32 v79, v79, v87
    v_add_f32 v80, v80, v88
    v_add_f32 v81, v81, v89
    v_add_f32 v82, v82, v90
    v_add_f32 v83, v83, v91
    v_cvt_pk_bf16_f32 v140, v76, v77
    v_cvt_pk_bf16_f32 v141, v78, v79
    v_cvt_pk_bf16_f32 v142, v80, v81
    v_cvt_pk_bf16_f32 v143, v82, v83
    buffer_store_dwordx4 v[140:143], v8, s[4:7], s17 offen offset:0 sc1
    s_waitcnt lgkmcnt(8)
    v_add_f32 v92, v92, v100
    v_add_f32 v93, v93, v101
    v_add_f32 v94, v94, v102
    v_add_f32 v95, v95, v103
    v_add_f32 v96, v96, v104
    v_add_f32 v97, v97, v105
    v_add_f32 v98, v98, v106
    v_add_f32 v99, v99, v107
    v_cvt_pk_bf16_f32 v144, v92, v93
    v_cvt_pk_bf16_f32 v145, v94, v95
    v_cvt_pk_bf16_f32 v146, v96, v97
    v_cvt_pk_bf16_f32 v147, v98, v99
    buffer_store_dwordx4 v[144:147], v8, s[4:7], s17 offen offset:1024 sc1
    s_cmp_eq_u32 s57, 0
    s_cbranch_scc1 CV_f1
    s_lshl_b32 s17, s12, 10
    s_lshl_b32 s15, s28, 12
    s_add_u32 s16, s17, s15
    s_add_u32 s16, s16, 4194304
    s_waitcnt lgkmcnt(0)
    v_add_f32 v44, v44, v52
    v_add_f32 v45, v45, v53
    v_add_f32 v46, v46, v54
    v_add_f32 v47, v47, v55
    v_add_f32 v48, v48, v56
    v_add_f32 v49, v49, v57
    v_add_f32 v50, v50, v58
    v_add_f32 v51, v51, v59
    v_add_f32 v44, v44, v60
    v_add_f32 v45, v45, v61
    v_add_f32 v46, v46, v62
    v_add_f32 v47, v47, v63
    v_add_f32 v48, v48, v64
    v_add_f32 v49, v49, v65
    v_add_f32 v50, v50, v66
    v_add_f32 v51, v51, v67
    v_add_f32 v44, v44, v68
    v_add_f32 v45, v45, v69
    v_add_f32 v46, v46, v70
    v_add_f32 v47, v47, v71
    v_add_f32 v48, v48, v72
    v_add_f32 v49, v49, v73
    v_add_f32 v50, v50, v74
    v_add_f32 v51, v51, v75
    v_cvt_pk_bf16_f32 v148, v44, v45
    v_cvt_pk_bf16_f32 v149, v46, v47
    v_cvt_pk_bf16_f32 v150, v48, v49
    v_cvt_pk_bf16_f32 v151, v50, v51
    buffer_store_dwordx4 v[148:151], v8, s[4:7], s16 offen sc1
    s_lshl_b32 s15, s28, 7
    s_lshl_b32 s16, s12, 2
    s_add_u32 s15, s15, s16
    s_add_u32 s15, s15, 22413312
    s_waitcnt vmcnt(0)
    s_mov_b64 exec, 1
    buffer_store_dword v180, v6, s[4:7], s15 offen sc1
    s_branch CV_f2
CV_f1:
    s_waitcnt vmcnt(0)
CV_f2:
    s_mov_b64 exec, 3
    buffer_store_dword v180, v4, s[4:7], s22 offen sc1
S_end:
    s_endpgm
K_exit:
    s_endpgm
.p2align 15
.section .rodata,"a"
.p2align 6
.amdhsa_kernel recurrent_scan__ssm_conv_s4__dense_activation_mish__prompt_kernel
  .amdhsa_next_free_vgpr 256
  .amdhsa_next_free_sgpr 64
  .amdhsa_accum_offset 256
  .amdhsa_group_segment_fixed_size 0
  .amdhsa_kernarg_size 128
  .amdhsa_user_sgpr_count 2
  .amdhsa_user_sgpr_kernarg_segment_ptr 1
  .amdhsa_system_sgpr_workgroup_id_x 1
  .amdhsa_float_denorm_mode_32 3
  .amdhsa_float_denorm_mode_16_64 3
.end_amdhsa_kernel
```
